```python
import torch

def _softmax(x, axis=-1):
    return torch.softmax(x, dim=axis)
def _gelu(x):
    return torch.nn.functional.gelu(x, approximate="tanh")
def _silu(x):
    return torch.nn.functional.silu(x)
def _sigmoid(x):
    return torch.sigmoid(x)
def _layernorm(x, axis=-1, eps=1e-5):
    m = x.mean(dim=axis, keepdim=True)
    v = x.var(dim=axis, keepdim=True, unbiased=False)
    return (x - m) / torch.sqrt(v + eps)
def _scatter_add(tgt, idx, src, axis=0):
    return tgt.clone().index_add_(axis, idx, src)
def _segment_sum(src, seg, n):
    out = torch.zeros((n,) + src.shape[1:], dtype=src.dtype)
    return out.index_add_(0, seg, src)
def _pad(x, pw):
    flat = tuple(v for pair in reversed(pw) for v in pair)
    return torch.nn.functional.pad(x, flat)

kernel_name = 'standalone__mha_softmax__decode'

def setup_inputs():

    _w = (lambda a: (lambda t: t.to(torch.bfloat16) if t.is_floating_point() else t)(torch.as_tensor(a)))
    B, H, Sq, Sk, D = 1, 32, 1, 8192, 128
    return {
        "q": _w((lambda *s: torch.randn(*s, dtype=torch.bfloat16) * 0.8)(B, H, Sq, D)),
        "k": _w((lambda *s: torch.randn(*s, dtype=torch.bfloat16) * 0.8)(B, H, Sk, D)),
        "v": _w((lambda *s: torch.randn(*s, dtype=torch.bfloat16) * 0.05)(B, H, Sk, D)),
    }

def reference(q, k, v):
    scale = q.shape[-1] ** -0.5
    scores = torch.einsum("bhqd,bhkd->bhqk", q, k) * scale
    p = _softmax(scores, axis=-1)
    return torch.einsum("bhqk,bhkd->bhqd", p, v)
```

```asm
; @launch grid=(256,1,1) block=(320,1,1) lds=2080
.amdgcn_target "amdgcn-amd-amdhsa--gfx950"
.text
.globl standalone__mha_softmax__decode_kernel
.p2align 8
.type standalone__mha_softmax__decode_kernel,@function
standalone__mha_softmax__decode_kernel:
    s_load_dwordx8 s[4:11], s[0:1], 0
    s_load_dwordx4 s[12:15], s[0:1], 32
    s_cmpk_ge_u32 s2, 256
    s_cbranch_scc1 L_end
    v_lshrrev_b32 v3, 6, v0
    s_getpc_b64 s[22:23]
    v_lshlrev_b32 v4, 7, v0
    v_min_u32 v4, L_end-.-64, v4
    global_load_dword v5, v4, s[22:23]
    v_readfirstlane_b32 s16, v3
    v_and_b32 v0, 63, v0
    s_lshl_b32 s21, s16, 8
    s_or_b32 s21, s21, s2
    s_bitcmp1_b32 s21, 0
    s_cselect_b32 s19, 4096, 0
    s_bitcmp1_b32 s21, 1
    s_cselect_b32 s3, 16384, 0
    s_xor_b32 s19, s19, s3
    s_bitcmp1_b32 s21, 2
    s_cselect_b32 s3, 8192, 0
    s_xor_b32 s19, s19, s3
    s_bitcmp1_b32 s21, 3
    s_cselect_b32 s3, 2048, 0
    s_xor_b32 s19, s19, s3
    s_bitcmp1_b32 s21, 4
    s_cselect_b32 s3, 32768, 0
    s_xor_b32 s19, s19, s3
    s_bitcmp1_b32 s21, 5
    s_cselect_b32 s3, 66048, 0
    s_xor_b32 s19, s19, s3
    s_bitcmp1_b32 s21, 6
    s_cselect_b32 s3, 131200, 0
    s_xor_b32 s19, s19, s3
    s_bitcmp1_b32 s21, 7
    s_cselect_b32 s3, 262708, 0
    s_xor_b32 s19, s19, s3
    s_bitcmp1_b32 s21, 8
    s_cselect_b32 s3, 4, 0
    s_xor_b32 s19, s19, s3
    s_bitcmp1_b32 s21, 9
    s_cselect_b32 s3, 8, 0
    s_xor_b32 s19, s19, s3
    s_getreg_b32 s3, hwreg(HW_REG_XCC_ID, 0, 4)
    s_xor_b32 s3, s3, s21
    s_bitcmp1_b32 s3, 2
    s_cselect_b32 s3, 1092, 0
    s_xor_b32 s19, s19, s3
    s_bfe_u32 s18, s19, 0x30010
    s_bfe_u32 s17, s19, 0x5000b
    s_and_b32 s19, s19, 65532
    s_lshl_b32 s19, s19, 10
    s_cmp_eq_u32 s16, 4
    s_cbranch_scc1 L_finisher
    v_and_b32 v4, 3, v0
    v_lshlrev_b32 v4, 4, v4
    v_and_b32 v6, 48, v0
    v_lshl_add_u32 v4, v6, 2, v4
    v_and_b32 v7, 12, v0
    v_lshlrev_b32 v7, 6, v7
    v_add3_u32 v1, v7, v4, s19
    s_lshl_b32 s20, s17, 8
    v_add_u32 v4, s20, v4
    s_waitcnt lgkmcnt(0)
    global_load_dwordx4 v[8:11], v4, s[4:5]
    global_load_dwordx4 v[80:83], v1, s[6:7] nt
    global_load_dwordx4 v[84:87], v1, s[6:7] offset:1024 nt
    global_load_dwordx4 v[88:91], v1, s[6:7] offset:2048 nt
    global_load_dwordx4 v[92:95], v1, s[6:7] offset:3072 nt
    v_xor_b32 v1, 16384, v1
    global_load_dwordx4 v[96:99], v1, s[6:7] nt
    global_load_dwordx4 v[100:103], v1, s[6:7] offset:1024 nt
    global_load_dwordx4 v[104:107], v1, s[6:7] offset:2048 nt
    global_load_dwordx4 v[108:111], v1, s[6:7] offset:3072 nt
    v_and_b32 v7, 15, v0
    v_lshlrev_b32 v7, 4, v7
    v_lshl_add_u32 v2, v6, 6, v7
    v_add_u32 v2, s19, v2
    v_and_b32 v3, 15, v0
    v_lshlrev_b32 v3, 5, v3
    v_and_b32 v74, 16, v0
    s_lshl_b32 s3, s16, 9
    v_add3_u32 v74, v3, v74, s3
    v_and_b32 v3, 1, v0
    v_lshlrev_b32 v3, 4, v3
    s_mov_b32 s3, 0xffff
    v_lshlrev_b32 v3, v3, s3
    s_mov_b32 vcc_lo, 0x03030303
    s_mov_b32 vcc_hi, vcc_lo
    v_cndmask_b32 v16, 0, v3, vcc
    s_lshl_b64 vcc, vcc, 2
    v_cndmask_b32 v17, 0, v3, vcc
    s_lshl_b64 vcc, vcc, 2
    v_cndmask_b32 v18, 0, v3, vcc
    s_lshl_b64 vcc, vcc, 2
    v_cndmask_b32 v19, 0, v3, vcc
    s_mov_b32 vcc_lo, 0x000f000f
    s_mov_b32 vcc_hi, vcc_lo
    s_waitcnt vmcnt(8)
    v_mov_b32 v5, 0x3e0293ee
    v_cndmask_b32 v20, 0, v8, vcc
    v_cndmask_b32 v21, 0, v9, vcc
    v_cndmask_b32 v22, 0, v10, vcc
    v_cndmask_b32 v23, 0, v11, vcc
    s_lshl_b64 vcc, vcc, 4
    v_cndmask_b32 v24, 0, v8, vcc
    v_cndmask_b32 v25, 0, v9, vcc
    v_cndmask_b32 v26, 0, v10, vcc
    v_cndmask_b32 v27, 0, v11, vcc
    s_lshl_b64 vcc, vcc, 4
    v_cndmask_b32 v28, 0, v8, vcc
    v_cndmask_b32 v29, 0, v9, vcc
    v_cndmask_b32 v30, 0, v10, vcc
    v_cndmask_b32 v31, 0, v11, vcc
    s_lshl_b64 vcc, vcc, 4
    v_cndmask_b32 v32, 0, v8, vcc
    v_cndmask_b32 v33, 0, v9, vcc
    v_cndmask_b32 v34, 0, v10, vcc
    v_cndmask_b32 v35, 0, v11, vcc
    s_waitcnt vmcnt(4)
    s_nop 0
    v_mfma_f32_16x16x32_bf16 v[8:11], v[20:23], v[80:83], 0
    v_mfma_f32_16x16x32_bf16 v[8:11], v[24:27], v[84:87], v[8:11]
    v_mfma_f32_16x16x32_bf16 v[8:11], v[28:31], v[88:91], v[8:11]
    v_mfma_f32_16x16x32_bf16 v[8:11], v[32:35], v[92:95], v[8:11]
    v_xor_b32 v1, 81920, v1
    global_load_dwordx4 v[80:83], v1, s[6:7] nt
    global_load_dwordx4 v[84:87], v1, s[6:7] offset:1024 nt
    global_load_dwordx4 v[88:91], v1, s[6:7] offset:2048 nt
    global_load_dwordx4 v[92:95], v1, s[6:7] offset:3072 nt
    s_nop 2
    v_mov_b32_dpp v36, v8 quad_perm:[0,0,0,0] row_mask:0xf bank_mask:0xf
    v_mov_b32_dpp v3, v9 quad_perm:[1,1,1,1] row_mask:0xf bank_mask:0xf
    s_nop 0
    v_add_f32_dpp v36, v10, v36 quad_perm:[2,2,2,2] row_mask:0xf bank_mask:0xf
    v_add_f32_dpp v3, v11, v3 quad_perm:[3,3,3,3] row_mask:0xf bank_mask:0xf
    v_add_f32 v36, v36, v3
    s_waitcnt vmcnt(4)
    v_mfma_f32_16x16x32_bf16 v[8:11], v[20:23], v[96:99], 0
    v_mfma_f32_16x16x32_bf16 v[8:11], v[24:27], v[100:103], v[8:11]
    v_mfma_f32_16x16x32_bf16 v[8:11], v[28:31], v[104:107], v[8:11]
    v_mfma_f32_16x16x32_bf16 v[8:11], v[32:35], v[108:111], v[8:11]
    v_xor_b32 v1, 16384, v1
    global_load_dwordx4 v[96:99], v1, s[6:7] nt
    global_load_dwordx4 v[100:103], v1, s[6:7] offset:1024 nt
    global_load_dwordx4 v[104:107], v1, s[6:7] offset:2048 nt
    global_load_dwordx4 v[108:111], v1, s[6:7] offset:3072 nt
    s_nop 2
    v_mov_b32_dpp v37, v8 quad_perm:[0,0,0,0] row_mask:0xf bank_mask:0xf
    v_mov_b32_dpp v3, v9 quad_perm:[1,1,1,1] row_mask:0xf bank_mask:0xf
    s_nop 0
    v_add_f32_dpp v37, v10, v37 quad_perm:[2,2,2,2] row_mask:0xf bank_mask:0xf
    v_add_f32_dpp v3, v11, v3 quad_perm:[3,3,3,3] row_mask:0xf bank_mask:0xf
    v_add_f32 v37, v37, v3
    v_max_f32 v6, v36, v37
    s_waitcnt vmcnt(4)
    v_mfma_f32_16x16x32_bf16 v[8:11], v[20:23], v[80:83], 0
    v_mfma_f32_16x16x32_bf16 v[8:11], v[24:27], v[84:87], v[8:11]
    v_mfma_f32_16x16x32_bf16 v[8:11], v[28:31], v[88:91], v[8:11]
    v_mfma_f32_16x16x32_bf16 v[8:11], v[32:35], v[92:95], v[8:11]
    v_xor_b32 v1, 344064, v1
    global_load_dwordx4 v[80:83], v1, s[6:7] nt
    global_load_dwordx4 v[84:87], v1, s[6:7] offset:1024 nt
    global_load_dwordx4 v[88:91], v1, s[6:7] offset:2048 nt
    global_load_dwordx4 v[92:95], v1, s[6:7] offset:3072 nt
    s_nop 2
    v_mov_b32_dpp v38, v8 quad_perm:[0,0,0,0] row_mask:0xf bank_mask:0xf
    v_mov_b32_dpp v3, v9 quad_perm:[1,1,1,1] row_mask:0xf bank_mask:0xf
    s_nop 0
    v_add_f32_dpp v38, v10, v38 quad_perm:[2,2,2,2] row_mask:0xf bank_mask:0xf
    v_add_f32_dpp v3, v11, v3 quad_perm:[3,3,3,3] row_mask:0xf bank_mask:0xf
    v_add_f32 v38, v38, v3
    s_waitcnt vmcnt(4)
    v_mfma_f32_16x16x32_bf16 v[8:11], v[20:23], v[96:99], 0
    v_mfma_f32_16x16x32_bf16 v[8:11], v[24:27], v[100:103], v[8:11]
    v_mfma_f32_16x16x32_bf16 v[8:11], v[28:31], v[104:107], v[8:11]
    v_mfma_f32_16x16x32_bf16 v[8:11], v[32:35], v[108:111], v[8:11]
    v_xor_b32 v1, 16384, v1
    global_load_dwordx4 v[96:99], v1, s[6:7] nt
    global_load_dwordx4 v[100:103], v1, s[6:7] offset:1024 nt
    global_load_dwordx4 v[104:107], v1, s[6:7] offset:2048 nt
    global_load_dwordx4 v[108:111], v1, s[6:7] offset:3072 nt
    s_nop 2
    v_mov_b32_dpp v39, v8 quad_perm:[0,0,0,0] row_mask:0xf bank_mask:0xf
    v_mov_b32_dpp v3, v9 quad_perm:[1,1,1,1] row_mask:0xf bank_mask:0xf
    s_nop 0
    v_add_f32_dpp v39, v10, v39 quad_perm:[2,2,2,2] row_mask:0xf bank_mask:0xf
    v_add_f32_dpp v3, v11, v3 quad_perm:[3,3,3,3] row_mask:0xf bank_mask:0xf
    v_add_f32 v39, v39, v3
    v_max3_f32 v6, v6, v38, v39
    s_waitcnt vmcnt(4)
    v_mfma_f32_16x16x32_bf16 v[8:11], v[20:23], v[80:83], 0
    v_mfma_f32_16x16x32_bf16 v[8:11], v[24:27], v[84:87], v[8:11]
    v_mfma_f32_16x16x32_bf16 v[8:11], v[28:31], v[88:91], v[8:11]
    v_mfma_f32_16x16x32_bf16 v[8:11], v[32:35], v[92:95], v[8:11]
    v_xor_b32 v1, 81920, v1
    global_load_dwordx4 v[80:83], v1, s[6:7] nt
    global_load_dwordx4 v[84:87], v1, s[6:7] offset:1024 nt
    global_load_dwordx4 v[88:91], v1, s[6:7] offset:2048 nt
    global_load_dwordx4 v[92:95], v1, s[6:7] offset:3072 nt
    s_nop 2
    v_mov_b32_dpp v40, v8 quad_perm:[0,0,0,0] row_mask:0xf bank_mask:0xf
    v_mov_b32_dpp v3, v9 quad_perm:[1,1,1,1] row_mask:0xf bank_mask:0xf
    s_nop 0
    v_add_f32_dpp v40, v10, v40 quad_perm:[2,2,2,2] row_mask:0xf bank_mask:0xf
    v_add_f32_dpp v3, v11, v3 quad_perm:[3,3,3,3] row_mask:0xf bank_mask:0xf
    v_add_f32 v40, v40, v3
    s_waitcnt vmcnt(4)
    v_mfma_f32_16x16x32_bf16 v[8:11], v[20:23], v[96:99], 0
    v_mfma_f32_16x16x32_bf16 v[8:11], v[24:27], v[100:103], v[8:11]
    v_mfma_f32_16x16x32_bf16 v[8:11], v[28:31], v[104:107], v[8:11]
    v_mfma_f32_16x16x32_bf16 v[8:11], v[32:35], v[108:111], v[8:11]
    v_xor_b32 v1, 16384, v1
    global_load_dwordx4 v[96:99], v1, s[6:7] nt
    global_load_dwordx4 v[100:103], v1, s[6:7] offset:1024 nt
    global_load_dwordx4 v[104:107], v1, s[6:7] offset:2048 nt
    global_load_dwordx4 v[108:111], v1, s[6:7] offset:3072 nt
    s_nop 2
    v_mov_b32_dpp v41, v8 quad_perm:[0,0,0,0] row_mask:0xf bank_mask:0xf
    v_mov_b32_dpp v3, v9 quad_perm:[1,1,1,1] row_mask:0xf bank_mask:0xf
    s_nop 0
    v_add_f32_dpp v41, v10, v41 quad_perm:[2,2,2,2] row_mask:0xf bank_mask:0xf
    v_add_f32_dpp v3, v11, v3 quad_perm:[3,3,3,3] row_mask:0xf bank_mask:0xf
    v_add_f32 v41, v41, v3
    v_max3_f32 v6, v6, v40, v41
    s_waitcnt vmcnt(4)
    v_mfma_f32_16x16x32_bf16 v[8:11], v[20:23], v[80:83], 0
    v_mfma_f32_16x16x32_bf16 v[8:11], v[24:27], v[84:87], v[8:11]
    v_mfma_f32_16x16x32_bf16 v[8:11], v[28:31], v[88:91], v[8:11]
    v_mfma_f32_16x16x32_bf16 v[8:11], v[32:35], v[92:95], v[8:11]
    v_xor_b32 v1, 1331200, v1
    global_load_dwordx4 v[80:83], v1, s[6:7] nt
    global_load_dwordx4 v[84:87], v1, s[6:7] offset:1024 nt
    global_load_dwordx4 v[88:91], v1, s[6:7] offset:2048 nt
    global_load_dwordx4 v[92:95], v1, s[6:7] offset:3072 nt
    s_nop 2
    v_mov_b32_dpp v42, v8 quad_perm:[0,0,0,0] row_mask:0xf bank_mask:0xf
    v_mov_b32_dpp v3, v9 quad_perm:[1,1,1,1] row_mask:0xf bank_mask:0xf
    s_nop 0
    v_add_f32_dpp v42, v10, v42 quad_perm:[2,2,2,2] row_mask:0xf bank_mask:0xf
    v_add_f32_dpp v3, v11, v3 quad_perm:[3,3,3,3] row_mask:0xf bank_mask:0xf
    v_add_f32 v42, v42, v3
    s_waitcnt vmcnt(4)
    v_mfma_f32_16x16x32_bf16 v[8:11], v[20:23], v[96:99], 0
    v_mfma_f32_16x16x32_bf16 v[8:11], v[24:27], v[100:103], v[8:11]
    v_mfma_f32_16x16x32_bf16 v[8:11], v[28:31], v[104:107], v[8:11]
    v_mfma_f32_16x16x32_bf16 v[8:11], v[32:35], v[108:111], v[8:11]
    v_xor_b32 v1, 16384, v1
    global_load_dwordx4 v[96:99], v1, s[6:7] nt
    global_load_dwordx4 v[100:103], v1, s[6:7] offset:1024 nt
    global_load_dwordx4 v[104:107], v1, s[6:7] offset:2048 nt
    global_load_dwordx4 v[108:111], v1, s[6:7] offset:3072 nt
    s_nop 2
    v_mov_b32_dpp v43, v8 quad_perm:[0,0,0,0] row_mask:0xf bank_mask:0xf
    v_mov_b32_dpp v3, v9 quad_perm:[1,1,1,1] row_mask:0xf bank_mask:0xf
    s_nop 0
    v_add_f32_dpp v43, v10, v43 quad_perm:[2,2,2,2] row_mask:0xf bank_mask:0xf
    v_add_f32_dpp v3, v11, v3 quad_perm:[3,3,3,3] row_mask:0xf bank_mask:0xf
    v_add_f32 v43, v43, v3
    v_max3_f32 v6, v6, v42, v43
    s_waitcnt vmcnt(4)
    v_mfma_f32_16x16x32_bf16 v[8:11], v[20:23], v[80:83], 0
    v_mfma_f32_16x16x32_bf16 v[8:11], v[24:27], v[84:87], v[8:11]
    v_mfma_f32_16x16x32_bf16 v[8:11], v[28:31], v[88:91], v[8:11]
    v_mfma_f32_16x16x32_bf16 v[8:11], v[32:35], v[92:95], v[8:11]
    v_xor_b32 v1, 81920, v1
    global_load_dwordx4 v[80:83], v1, s[6:7] nt
    global_load_dwordx4 v[84:87], v1, s[6:7] offset:1024 nt
    global_load_dwordx4 v[88:91], v1, s[6:7] offset:2048 nt
    global_load_dwordx4 v[92:95], v1, s[6:7] offset:3072 nt
    s_nop 2
    v_mov_b32_dpp v44, v8 quad_perm:[0,0,0,0] row_mask:0xf bank_mask:0xf
    v_mov_b32_dpp v3, v9 quad_perm:[1,1,1,1] row_mask:0xf bank_mask:0xf
    s_nop 0
    v_add_f32_dpp v44, v10, v44 quad_perm:[2,2,2,2] row_mask:0xf bank_mask:0xf
    v_add_f32_dpp v3, v11, v3 quad_perm:[3,3,3,3] row_mask:0xf bank_mask:0xf
    v_add_f32 v44, v44, v3
    s_waitcnt vmcnt(4)
    v_mfma_f32_16x16x32_bf16 v[8:11], v[20:23], v[96:99], 0
    v_mfma_f32_16x16x32_bf16 v[8:11], v[24:27], v[100:103], v[8:11]
    v_mfma_f32_16x16x32_bf16 v[8:11], v[28:31], v[104:107], v[8:11]
    v_mfma_f32_16x16x32_bf16 v[8:11], v[32:35], v[108:111], v[8:11]
    v_xor_b32 v1, 16384, v1
    global_load_dwordx4 v[96:99], v1, s[6:7] nt
    global_load_dwordx4 v[100:103], v1, s[6:7] offset:1024 nt
    global_load_dwordx4 v[104:107], v1, s[6:7] offset:2048 nt
    global_load_dwordx4 v[108:111], v1, s[6:7] offset:3072 nt
    s_nop 2
    v_mov_b32_dpp v45, v8 quad_perm:[0,0,0,0] row_mask:0xf bank_mask:0xf
    v_mov_b32_dpp v3, v9 quad_perm:[1,1,1,1] row_mask:0xf bank_mask:0xf
    s_nop 0
    v_add_f32_dpp v45, v10, v45 quad_perm:[2,2,2,2] row_mask:0xf bank_mask:0xf
    v_add_f32_dpp v3, v11, v3 quad_perm:[3,3,3,3] row_mask:0xf bank_mask:0xf
    v_add_f32 v45, v45, v3
    v_max3_f32 v6, v6, v44, v45
    s_waitcnt vmcnt(4)
    v_mfma_f32_16x16x32_bf16 v[8:11], v[20:23], v[80:83], 0
    v_mfma_f32_16x16x32_bf16 v[8:11], v[24:27], v[84:87], v[8:11]
    v_mfma_f32_16x16x32_bf16 v[8:11], v[28:31], v[88:91], v[8:11]
    v_mfma_f32_16x16x32_bf16 v[8:11], v[32:35], v[92:95], v[8:11]
    v_xor_b32 v1, 344064, v1
    global_load_dwordx4 v[80:83], v1, s[6:7] nt
    global_load_dwordx4 v[84:87], v1, s[6:7] offset:1024 nt
    global_load_dwordx4 v[88:91], v1, s[6:7] offset:2048 nt
    global_load_dwordx4 v[92:95], v1, s[6:7] offset:3072 nt
    s_nop 2
    v_mov_b32_dpp v46, v8 quad_perm:[0,0,0,0] row_mask:0xf bank_mask:0xf
    v_mov_b32_dpp v3, v9 quad_perm:[1,1,1,1] row_mask:0xf bank_mask:0xf
    s_nop 0
    v_add_f32_dpp v46, v10, v46 quad_perm:[2,2,2,2] row_mask:0xf bank_mask:0xf
    v_add_f32_dpp v3, v11, v3 quad_perm:[3,3,3,3] row_mask:0xf bank_mask:0xf
    v_add_f32 v46, v46, v3
    s_waitcnt vmcnt(4)
    v_mfma_f32_16x16x32_bf16 v[8:11], v[20:23], v[96:99], 0
    v_mfma_f32_16x16x32_bf16 v[8:11], v[24:27], v[100:103], v[8:11]
    v_mfma_f32_16x16x32_bf16 v[8:11], v[28:31], v[104:107], v[8:11]
    v_mfma_f32_16x16x32_bf16 v[8:11], v[32:35], v[108:111], v[8:11]
    v_xor_b32 v1, 16384, v1
    global_load_dwordx4 v[96:99], v1, s[6:7] nt
    global_load_dwordx4 v[100:103], v1, s[6:7] offset:1024 nt
    global_load_dwordx4 v[104:107], v1, s[6:7] offset:2048 nt
    global_load_dwordx4 v[108:111], v1, s[6:7] offset:3072 nt
    s_nop 2
    v_mov_b32_dpp v47, v8 quad_perm:[0,0,0,0] row_mask:0xf bank_mask:0xf
    v_mov_b32_dpp v3, v9 quad_perm:[1,1,1,1] row_mask:0xf bank_mask:0xf
    s_nop 0
    v_add_f32_dpp v47, v10, v47 quad_perm:[2,2,2,2] row_mask:0xf bank_mask:0xf
    v_add_f32_dpp v3, v11, v3 quad_perm:[3,3,3,3] row_mask:0xf bank_mask:0xf
    v_add_f32 v47, v47, v3
    v_max3_f32 v6, v6, v46, v47
    s_waitcnt vmcnt(4)
    v_mfma_f32_16x16x32_bf16 v[8:11], v[20:23], v[80:83], 0
    v_mfma_f32_16x16x32_bf16 v[8:11], v[24:27], v[84:87], v[8:11]
    v_mfma_f32_16x16x32_bf16 v[8:11], v[28:31], v[88:91], v[8:11]
    v_mfma_f32_16x16x32_bf16 v[8:11], v[32:35], v[92:95], v[8:11]
    v_xor_b32 v1, 81920, v1
    global_load_dwordx4 v[80:83], v1, s[6:7] nt
    global_load_dwordx4 v[84:87], v1, s[6:7] offset:1024 nt
    global_load_dwordx4 v[88:91], v1, s[6:7] offset:2048 nt
    global_load_dwordx4 v[92:95], v1, s[6:7] offset:3072 nt
    s_nop 2
    v_mov_b32_dpp v48, v8 quad_perm:[0,0,0,0] row_mask:0xf bank_mask:0xf
    v_mov_b32_dpp v3, v9 quad_perm:[1,1,1,1] row_mask:0xf bank_mask:0xf
    s_nop 0
    v_add_f32_dpp v48, v10, v48 quad_perm:[2,2,2,2] row_mask:0xf bank_mask:0xf
    v_add_f32_dpp v3, v11, v3 quad_perm:[3,3,3,3] row_mask:0xf bank_mask:0xf
    v_add_f32 v48, v48, v3
    s_waitcnt vmcnt(4)
    v_mfma_f32_16x16x32_bf16 v[8:11], v[20:23], v[96:99], 0
    v_mfma_f32_16x16x32_bf16 v[8:11], v[24:27], v[100:103], v[8:11]
    v_mfma_f32_16x16x32_bf16 v[8:11], v[28:31], v[104:107], v[8:11]
    v_mfma_f32_16x16x32_bf16 v[8:11], v[32:35], v[108:111], v[8:11]
    v_xor_b32 v1, 16384, v1
    global_load_dwordx4 v[96:99], v1, s[6:7] nt
    global_load_dwordx4 v[100:103], v1, s[6:7] offset:1024 nt
    global_load_dwordx4 v[104:107], v1, s[6:7] offset:2048 nt
    global_load_dwordx4 v[108:111], v1, s[6:7] offset:3072 nt
    s_nop 2
    v_mov_b32_dpp v49, v8 quad_perm:[0,0,0,0] row_mask:0xf bank_mask:0xf
    v_mov_b32_dpp v3, v9 quad_perm:[1,1,1,1] row_mask:0xf bank_mask:0xf
    s_nop 0
    v_add_f32_dpp v49, v10, v49 quad_perm:[2,2,2,2] row_mask:0xf bank_mask:0xf
    v_add_f32_dpp v3, v11, v3 quad_perm:[3,3,3,3] row_mask:0xf bank_mask:0xf
    v_add_f32 v49, v49, v3
    v_max3_f32 v6, v6, v48, v49
    s_waitcnt vmcnt(4)
    v_mfma_f32_16x16x32_bf16 v[8:11], v[20:23], v[80:83], 0
    v_mfma_f32_16x16x32_bf16 v[8:11], v[24:27], v[84:87], v[8:11]
    v_mfma_f32_16x16x32_bf16 v[8:11], v[28:31], v[88:91], v[8:11]
    v_mfma_f32_16x16x32_bf16 v[8:11], v[32:35], v[92:95], v[8:11]
    global_load_dwordx4 v[80:83], v2, s[8:9] nt
    global_load_dwordx4 v[84:87], v2, s[8:9] offset:256 nt
    global_load_dwordx4 v[88:91], v2, s[8:9] offset:512 nt
    global_load_dwordx4 v[92:95], v2, s[8:9] offset:768 nt
    s_nop 3
    v_mov_b32_dpp v50, v8 quad_perm:[0,0,0,0] row_mask:0xf bank_mask:0xf
    v_mov_b32_dpp v3, v9 quad_perm:[1,1,1,1] row_mask:0xf bank_mask:0xf
    s_nop 0
    v_add_f32_dpp v50, v10, v50 quad_perm:[2,2,2,2] row_mask:0xf bank_mask:0xf
    v_add_f32_dpp v3, v11, v3 quad_perm:[3,3,3,3] row_mask:0xf bank_mask:0xf
    v_add_f32 v50, v50, v3
    s_waitcnt vmcnt(4)
    v_mfma_f32_16x16x32_bf16 v[8:11], v[20:23], v[96:99], 0
    v_mfma_f32_16x16x32_bf16 v[8:11], v[24:27], v[100:103], v[8:11]
    v_mfma_f32_16x16x32_bf16 v[8:11], v[28:31], v[104:107], v[8:11]
    v_mfma_f32_16x16x32_bf16 v[8:11], v[32:35], v[108:111], v[8:11]
    v_xor_b32 v2, 16384, v2
    global_load_dwordx4 v[96:99], v2, s[8:9] nt
    global_load_dwordx4 v[100:103], v2, s[8:9] offset:256 nt
    global_load_dwordx4 v[104:107], v2, s[8:9] offset:512 nt
    global_load_dwordx4 v[108:111], v2, s[8:9] offset:768 nt
    s_nop 2
    v_mov_b32_dpp v51, v8 quad_perm:[0,0,0,0] row_mask:0xf bank_mask:0xf
    v_mov_b32_dpp v3, v9 quad_perm:[1,1,1,1] row_mask:0xf bank_mask:0xf
    s_nop 0
    v_add_f32_dpp v51, v10, v51 quad_perm:[2,2,2,2] row_mask:0xf bank_mask:0xf
    v_add_f32_dpp v3, v11, v3 quad_perm:[3,3,3,3] row_mask:0xf bank_mask:0xf
    v_add_f32 v51, v51, v3
    v_max3_f32 v6, v6, v50, v51
    s_nop 1
    v_max_f32_dpp v6, v6, v6 row_ror:4 row_mask:0xf bank_mask:0xf
    s_nop 1
    v_max_f32_dpp v6, v6, v6 row_ror:8 row_mask:0xf bank_mask:0xf
    s_nop 1
    v_max_f32_dpp v6, v6, v6 row_bcast:15 row_mask:0xa bank_mask:0xf
    s_nop 1
    v_max_f32_dpp v6, v6, v6 row_bcast:31 row_mask:0xc bank_mask:0xf
    v_mul_f32 v6, v5, v6
    s_nop 0
    v_readlane_b32 s22, v6, 63
    s_nop 1
    v_fma_f32 v36, v36, v5, -s22
    v_exp_f32 v36, v36
    v_mov_b32 v6, s22
    v_mov_b32 v7, v36
    v_cvt_pk_bf16_f32 v36, v36, v36
    s_nop 1
    v_and_b32_dpp v20, v36, v16 row_newbcast:0 row_mask:0xf bank_mask:0xf
    v_and_b32_dpp v21, v36, v17 row_newbcast:0 row_mask:0xf bank_mask:0xf
    v_and_b32_dpp v22, v36, v18 row_newbcast:0 row_mask:0xf bank_mask:0xf
    v_and_b32_dpp v23, v36, v19 row_newbcast:0 row_mask:0xf bank_mask:0xf
    v_and_b32_dpp v24, v36, v16 row_newbcast:4 row_mask:0xf bank_mask:0xf
    v_and_b32_dpp v25, v36, v17 row_newbcast:4 row_mask:0xf bank_mask:0xf
    v_and_b32_dpp v26, v36, v18 row_newbcast:4 row_mask:0xf bank_mask:0xf
    v_and_b32_dpp v27, v36, v19 row_newbcast:4 row_mask:0xf bank_mask:0xf
    v_and_b32_dpp v28, v36, v16 row_newbcast:8 row_mask:0xf bank_mask:0xf
    v_and_b32_dpp v29, v36, v17 row_newbcast:8 row_mask:0xf bank_mask:0xf
    v_and_b32_dpp v30, v36, v18 row_newbcast:8 row_mask:0xf bank_mask:0xf
    v_and_b32_dpp v31, v36, v19 row_newbcast:8 row_mask:0xf bank_mask:0xf
    v_and_b32_dpp v32, v36, v16 row_newbcast:12 row_mask:0xf bank_mask:0xf
    v_and_b32_dpp v33, v36, v17 row_newbcast:12 row_mask:0xf bank_mask:0xf
    v_and_b32_dpp v34, v36, v18 row_newbcast:12 row_mask:0xf bank_mask:0xf
    v_and_b32_dpp v35, v36, v19 row_newbcast:12 row_mask:0xf bank_mask:0xf
    s_waitcnt vmcnt(4)
    s_nop 0
    v_mfma_f32_16x16x32_bf16 v[8:11], v[20:23], v[80:83], 0
    v_mfma_f32_16x16x32_bf16 v[8:11], v[24:27], v[84:87], v[8:11]
    v_mfma_f32_16x16x32_bf16 v[8:11], v[28:31], v[88:91], v[8:11]
    v_mfma_f32_16x16x32_bf16 v[8:11], v[32:35], v[92:95], v[8:11]
    v_xor_b32 v2, 81920, v2
    global_load_dwordx4 v[80:83], v2, s[8:9] nt
    global_load_dwordx4 v[84:87], v2, s[8:9] offset:256 nt
    global_load_dwordx4 v[88:91], v2, s[8:9] offset:512 nt
    global_load_dwordx4 v[92:95], v2, s[8:9] offset:768 nt
    v_fma_f32 v37, v37, v5, -s22
    v_fma_f32 v38, v38, v5, -s22
    v_exp_f32 v37, v37
    v_exp_f32 v38, v38
    s_nop 0
    v_add_f32 v7, v7, v37
    v_add_f32 v7, v7, v38
    v_cvt_pk_bf16_f32 v37, v37, v37
    v_cvt_pk_bf16_f32 v38, v38, v38
    s_nop 1
    v_and_b32_dpp v20, v37, v16 row_newbcast:0 row_mask:0xf bank_mask:0xf
    v_and_b32_dpp v21, v37, v17 row_newbcast:0 row_mask:0xf bank_mask:0xf
    v_and_b32_dpp v22, v37, v18 row_newbcast:0 row_mask:0xf bank_mask:0xf
    v_and_b32_dpp v23, v37, v19 row_newbcast:0 row_mask:0xf bank_mask:0xf
    v_and_b32_dpp v24, v37, v16 row_newbcast:4 row_mask:0xf bank_mask:0xf
    v_and_b32_dpp v25, v37, v17 row_newbcast:4 row_mask:0xf bank_mask:0xf
    v_and_b32_dpp v26, v37, v18 row_newbcast:4 row_mask:0xf bank_mask:0xf
    v_and_b32_dpp v27, v37, v19 row_newbcast:4 row_mask:0xf bank_mask:0xf
    v_and_b32_dpp v28, v37, v16 row_newbcast:8 row_mask:0xf bank_mask:0xf
    v_and_b32_dpp v29, v37, v17 row_newbcast:8 row_mask:0xf bank_mask:0xf
    v_and_b32_dpp v30, v37, v18 row_newbcast:8 row_mask:0xf bank_mask:0xf
    v_and_b32_dpp v31, v37, v19 row_newbcast:8 row_mask:0xf bank_mask:0xf
    v_and_b32_dpp v32, v37, v16 row_newbcast:12 row_mask:0xf bank_mask:0xf
    v_and_b32_dpp v33, v37, v17 row_newbcast:12 row_mask:0xf bank_mask:0xf
    v_and_b32_dpp v34, v37, v18 row_newbcast:12 row_mask:0xf bank_mask:0xf
    v_and_b32_dpp v35, v37, v19 row_newbcast:12 row_mask:0xf bank_mask:0xf
    s_waitcnt vmcnt(4)
    s_nop 0
    v_mfma_f32_16x16x32_bf16 v[8:11], v[20:23], v[96:99], v[8:11]
    v_mfma_f32_16x16x32_bf16 v[8:11], v[24:27], v[100:103], v[8:11]
    v_mfma_f32_16x16x32_bf16 v[8:11], v[28:31], v[104:107], v[8:11]
    v_mfma_f32_16x16x32_bf16 v[8:11], v[32:35], v[108:111], v[8:11]
    v_xor_b32 v2, 16384, v2
    global_load_dwordx4 v[96:99], v2, s[8:9] nt
    global_load_dwordx4 v[100:103], v2, s[8:9] offset:256 nt
    global_load_dwordx4 v[104:107], v2, s[8:9] offset:512 nt
    global_load_dwordx4 v[108:111], v2, s[8:9] offset:768 nt
    v_fma_f32 v39, v39, v5, -s22
    v_fma_f32 v40, v40, v5, -s22
    v_exp_f32 v39, v39
    v_exp_f32 v40, v40
    s_nop 0
    v_add_f32 v7, v7, v39
    v_add_f32 v7, v7, v40
    v_cvt_pk_bf16_f32 v39, v39, v39
    v_cvt_pk_bf16_f32 v40, v40, v40
    s_nop 1
    v_and_b32_dpp v20, v38, v16 row_newbcast:0 row_mask:0xf bank_mask:0xf
    v_and_b32_dpp v21, v38, v17 row_newbcast:0 row_mask:0xf bank_mask:0xf
    v_and_b32_dpp v22, v38, v18 row_newbcast:0 row_mask:0xf bank_mask:0xf
    v_and_b32_dpp v23, v38, v19 row_newbcast:0 row_mask:0xf bank_mask:0xf
    v_and_b32_dpp v24, v38, v16 row_newbcast:4 row_mask:0xf bank_mask:0xf
    v_and_b32_dpp v25, v38, v17 row_newbcast:4 row_mask:0xf bank_mask:0xf
    v_and_b32_dpp v26, v38, v18 row_newbcast:4 row_mask:0xf bank_mask:0xf
    v_and_b32_dpp v27, v38, v19 row_newbcast:4 row_mask:0xf bank_mask:0xf
    v_and_b32_dpp v28, v38, v16 row_newbcast:8 row_mask:0xf bank_mask:0xf
    v_and_b32_dpp v29, v38, v17 row_newbcast:8 row_mask:0xf bank_mask:0xf
    v_and_b32_dpp v30, v38, v18 row_newbcast:8 row_mask:0xf bank_mask:0xf
    v_and_b32_dpp v31, v38, v19 row_newbcast:8 row_mask:0xf bank_mask:0xf
    v_and_b32_dpp v32, v38, v16 row_newbcast:12 row_mask:0xf bank_mask:0xf
    v_and_b32_dpp v33, v38, v17 row_newbcast:12 row_mask:0xf bank_mask:0xf
    v_and_b32_dpp v34, v38, v18 row_newbcast:12 row_mask:0xf bank_mask:0xf
    v_and_b32_dpp v35, v38, v19 row_newbcast:12 row_mask:0xf bank_mask:0xf
    s_waitcnt vmcnt(4)
    s_nop 0
    v_mfma_f32_16x16x32_bf16 v[8:11], v[20:23], v[80:83], v[8:11]
    v_mfma_f32_16x16x32_bf16 v[8:11], v[24:27], v[84:87], v[8:11]
    v_mfma_f32_16x16x32_bf16 v[8:11], v[28:31], v[88:91], v[8:11]
    v_mfma_f32_16x16x32_bf16 v[8:11], v[32:35], v[92:95], v[8:11]
    v_xor_b32 v2, 344064, v2
    global_load_dwordx4 v[80:83], v2, s[8:9] nt
    global_load_dwordx4 v[84:87], v2, s[8:9] offset:256 nt
    global_load_dwordx4 v[88:91], v2, s[8:9] offset:512 nt
    global_load_dwordx4 v[92:95], v2, s[8:9] offset:768 nt
    v_fma_f32 v41, v41, v5, -s22
    v_fma_f32 v42, v42, v5, -s22
    v_exp_f32 v41, v41
    v_exp_f32 v42, v42
    s_nop 0
    v_add_f32 v7, v7, v41
    v_add_f32 v7, v7, v42
    v_cvt_pk_bf16_f32 v41, v41, v41
    v_cvt_pk_bf16_f32 v42, v42, v42
    s_nop 1
    v_and_b32_dpp v20, v39, v16 row_newbcast:0 row_mask:0xf bank_mask:0xf
    v_and_b32_dpp v21, v39, v17 row_newbcast:0 row_mask:0xf bank_mask:0xf
    v_and_b32_dpp v22, v39, v18 row_newbcast:0 row_mask:0xf bank_mask:0xf
    v_and_b32_dpp v23, v39, v19 row_newbcast:0 row_mask:0xf bank_mask:0xf
    v_and_b32_dpp v24, v39, v16 row_newbcast:4 row_mask:0xf bank_mask:0xf
    v_and_b32_dpp v25, v39, v17 row_newbcast:4 row_mask:0xf bank_mask:0xf
    v_and_b32_dpp v26, v39, v18 row_newbcast:4 row_mask:0xf bank_mask:0xf
    v_and_b32_dpp v27, v39, v19 row_newbcast:4 row_mask:0xf bank_mask:0xf
    v_and_b32_dpp v28, v39, v16 row_newbcast:8 row_mask:0xf bank_mask:0xf
    v_and_b32_dpp v29, v39, v17 row_newbcast:8 row_mask:0xf bank_mask:0xf
    v_and_b32_dpp v30, v39, v18 row_newbcast:8 row_mask:0xf bank_mask:0xf
    v_and_b32_dpp v31, v39, v19 row_newbcast:8 row_mask:0xf bank_mask:0xf
    v_and_b32_dpp v32, v39, v16 row_newbcast:12 row_mask:0xf bank_mask:0xf
    v_and_b32_dpp v33, v39, v17 row_newbcast:12 row_mask:0xf bank_mask:0xf
    v_and_b32_dpp v34, v39, v18 row_newbcast:12 row_mask:0xf bank_mask:0xf
    v_and_b32_dpp v35, v39, v19 row_newbcast:12 row_mask:0xf bank_mask:0xf
    s_waitcnt vmcnt(4)
    s_nop 0
    v_mfma_f32_16x16x32_bf16 v[8:11], v[20:23], v[96:99], v[8:11]
    v_mfma_f32_16x16x32_bf16 v[8:11], v[24:27], v[100:103], v[8:11]
    v_mfma_f32_16x16x32_bf16 v[8:11], v[28:31], v[104:107], v[8:11]
    v_mfma_f32_16x16x32_bf16 v[8:11], v[32:35], v[108:111], v[8:11]
    v_xor_b32 v2, 16384, v2
    global_load_dwordx4 v[96:99], v2, s[8:9] nt
    global_load_dwordx4 v[100:103], v2, s[8:9] offset:256 nt
    global_load_dwordx4 v[104:107], v2, s[8:9] offset:512 nt
    global_load_dwordx4 v[108:111], v2, s[8:9] offset:768 nt
    v_fma_f32 v43, v43, v5, -s22
    v_fma_f32 v44, v44, v5, -s22
    v_exp_f32 v43, v43
    v_exp_f32 v44, v44
    s_nop 0
    v_add_f32 v7, v7, v43
    v_mov_b32 v4, v44
    v_cvt_pk_bf16_f32 v43, v43, v43
    v_cvt_pk_bf16_f32 v44, v44, v44
    s_nop 1
    v_and_b32_dpp v20, v40, v16 row_newbcast:0 row_mask:0xf bank_mask:0xf
    v_and_b32_dpp v21, v40, v17 row_newbcast:0 row_mask:0xf bank_mask:0xf
    v_and_b32_dpp v22, v40, v18 row_newbcast:0 row_mask:0xf bank_mask:0xf
    v_and_b32_dpp v23, v40, v19 row_newbcast:0 row_mask:0xf bank_mask:0xf
    v_and_b32_dpp v24, v40, v16 row_newbcast:4 row_mask:0xf bank_mask:0xf
    v_and_b32_dpp v25, v40, v17 row_newbcast:4 row_mask:0xf bank_mask:0xf
    v_and_b32_dpp v26, v40, v18 row_newbcast:4 row_mask:0xf bank_mask:0xf
    v_and_b32_dpp v27, v40, v19 row_newbcast:4 row_mask:0xf bank_mask:0xf
    v_and_b32_dpp v28, v40, v16 row_newbcast:8 row_mask:0xf bank_mask:0xf
    v_and_b32_dpp v29, v40, v17 row_newbcast:8 row_mask:0xf bank_mask:0xf
    v_and_b32_dpp v30, v40, v18 row_newbcast:8 row_mask:0xf bank_mask:0xf
    v_and_b32_dpp v31, v40, v19 row_newbcast:8 row_mask:0xf bank_mask:0xf
    v_and_b32_dpp v32, v40, v16 row_newbcast:12 row_mask:0xf bank_mask:0xf
    v_and_b32_dpp v33, v40, v17 row_newbcast:12 row_mask:0xf bank_mask:0xf
    v_and_b32_dpp v34, v40, v18 row_newbcast:12 row_mask:0xf bank_mask:0xf
    v_and_b32_dpp v35, v40, v19 row_newbcast:12 row_mask:0xf bank_mask:0xf
    s_waitcnt vmcnt(4)
    s_nop 0
    v_mfma_f32_16x16x32_bf16 v[8:11], v[20:23], v[80:83], v[8:11]
    v_mfma_f32_16x16x32_bf16 v[8:11], v[24:27], v[84:87], v[8:11]
    v_mfma_f32_16x16x32_bf16 v[8:11], v[28:31], v[88:91], v[8:11]
    v_mfma_f32_16x16x32_bf16 v[8:11], v[32:35], v[92:95], v[8:11]
    v_xor_b32 v2, 81920, v2
    global_load_dwordx4 v[80:83], v2, s[8:9] nt
    global_load_dwordx4 v[84:87], v2, s[8:9] offset:256 nt
    global_load_dwordx4 v[88:91], v2, s[8:9] offset:512 nt
    global_load_dwordx4 v[92:95], v2, s[8:9] offset:768 nt
    v_fma_f32 v45, v45, v5, -s22
    v_fma_f32 v46, v46, v5, -s22
    v_exp_f32 v45, v45
    v_exp_f32 v46, v46
    s_nop 0
    v_add_f32 v4, v4, v45
    v_add_f32 v4, v4, v46
    v_cvt_pk_bf16_f32 v45, v45, v45
    v_cvt_pk_bf16_f32 v46, v46, v46
    s_nop 1
    v_and_b32_dpp v20, v41, v16 row_newbcast:0 row_mask:0xf bank_mask:0xf
    v_and_b32_dpp v21, v41, v17 row_newbcast:0 row_mask:0xf bank_mask:0xf
    v_and_b32_dpp v22, v41, v18 row_newbcast:0 row_mask:0xf bank_mask:0xf
    v_and_b32_dpp v23, v41, v19 row_newbcast:0 row_mask:0xf bank_mask:0xf
    v_and_b32_dpp v24, v41, v16 row_newbcast:4 row_mask:0xf bank_mask:0xf
    v_and_b32_dpp v25, v41, v17 row_newbcast:4 row_mask:0xf bank_mask:0xf
    v_and_b32_dpp v26, v41, v18 row_newbcast:4 row_mask:0xf bank_mask:0xf
    v_and_b32_dpp v27, v41, v19 row_newbcast:4 row_mask:0xf bank_mask:0xf
    v_and_b32_dpp v28, v41, v16 row_newbcast:8 row_mask:0xf bank_mask:0xf
    v_and_b32_dpp v29, v41, v17 row_newbcast:8 row_mask:0xf bank_mask:0xf
    v_and_b32_dpp v30, v41, v18 row_newbcast:8 row_mask:0xf bank_mask:0xf
    v_and_b32_dpp v31, v41, v19 row_newbcast:8 row_mask:0xf bank_mask:0xf
    v_and_b32_dpp v32, v41, v16 row_newbcast:12 row_mask:0xf bank_mask:0xf
    v_and_b32_dpp v33, v41, v17 row_newbcast:12 row_mask:0xf bank_mask:0xf
    v_and_b32_dpp v34, v41, v18 row_newbcast:12 row_mask:0xf bank_mask:0xf
    v_and_b32_dpp v35, v41, v19 row_newbcast:12 row_mask:0xf bank_mask:0xf
    s_waitcnt vmcnt(4)
    s_nop 0
    v_mfma_f32_16x16x32_bf16 v[8:11], v[20:23], v[96:99], v[8:11]
    v_mfma_f32_16x16x32_bf16 v[8:11], v[24:27], v[100:103], v[8:11]
    v_mfma_f32_16x16x32_bf16 v[8:11], v[28:31], v[104:107], v[8:11]
    v_mfma_f32_16x16x32_bf16 v[8:11], v[32:35], v[108:111], v[8:11]
    v_xor_b32 v2, 16384, v2
    global_load_dwordx4 v[96:99], v2, s[8:9] nt
    global_load_dwordx4 v[100:103], v2, s[8:9] offset:256 nt
    global_load_dwordx4 v[104:107], v2, s[8:9] offset:512 nt
    global_load_dwordx4 v[108:111], v2, s[8:9] offset:768 nt
    v_fma_f32 v47, v47, v5, -s22
    v_fma_f32 v48, v48, v5, -s22
    v_exp_f32 v47, v47
    v_exp_f32 v48, v48
    s_nop 0
    v_add_f32 v4, v4, v47
    v_add_f32 v4, v4, v48
    v_cvt_pk_bf16_f32 v47, v47, v47
    v_cvt_pk_bf16_f32 v48, v48, v48
    s_nop 1
    v_and_b32_dpp v20, v42, v16 row_newbcast:0 row_mask:0xf bank_mask:0xf
    v_and_b32_dpp v21, v42, v17 row_newbcast:0 row_mask:0xf bank_mask:0xf
    v_and_b32_dpp v22, v42, v18 row_newbcast:0 row_mask:0xf bank_mask:0xf
    v_and_b32_dpp v23, v42, v19 row_newbcast:0 row_mask:0xf bank_mask:0xf
    v_and_b32_dpp v24, v42, v16 row_newbcast:4 row_mask:0xf bank_mask:0xf
    v_and_b32_dpp v25, v42, v17 row_newbcast:4 row_mask:0xf bank_mask:0xf
    v_and_b32_dpp v26, v42, v18 row_newbcast:4 row_mask:0xf bank_mask:0xf
    v_and_b32_dpp v27, v42, v19 row_newbcast:4 row_mask:0xf bank_mask:0xf
    v_and_b32_dpp v28, v42, v16 row_newbcast:8 row_mask:0xf bank_mask:0xf
    v_and_b32_dpp v29, v42, v17 row_newbcast:8 row_mask:0xf bank_mask:0xf
    v_and_b32_dpp v30, v42, v18 row_newbcast:8 row_mask:0xf bank_mask:0xf
    v_and_b32_dpp v31, v42, v19 row_newbcast:8 row_mask:0xf bank_mask:0xf
    v_and_b32_dpp v32, v42, v16 row_newbcast:12 row_mask:0xf bank_mask:0xf
    v_and_b32_dpp v33, v42, v17 row_newbcast:12 row_mask:0xf bank_mask:0xf
    v_and_b32_dpp v34, v42, v18 row_newbcast:12 row_mask:0xf bank_mask:0xf
    v_and_b32_dpp v35, v42, v19 row_newbcast:12 row_mask:0xf bank_mask:0xf
    s_waitcnt vmcnt(4)
    s_nop 0
    v_mfma_f32_16x16x32_bf16 v[8:11], v[20:23], v[80:83], v[8:11]
    v_mfma_f32_16x16x32_bf16 v[8:11], v[24:27], v[84:87], v[8:11]
    v_mfma_f32_16x16x32_bf16 v[8:11], v[28:31], v[88:91], v[8:11]
    v_mfma_f32_16x16x32_bf16 v[8:11], v[32:35], v[92:95], v[8:11]
    v_xor_b32 v2, 1331200, v2
    global_load_dwordx4 v[80:83], v2, s[8:9] nt
    global_load_dwordx4 v[84:87], v2, s[8:9] offset:256 nt
    global_load_dwordx4 v[88:91], v2, s[8:9] offset:512 nt
    global_load_dwordx4 v[92:95], v2, s[8:9] offset:768 nt
    v_fma_f32 v49, v49, v5, -s22
    v_fma_f32 v50, v50, v5, -s22
    v_exp_f32 v49, v49
    v_exp_f32 v50, v50
    s_nop 0
    v_add_f32 v4, v4, v49
    v_add_f32 v4, v4, v50
    v_cvt_pk_bf16_f32 v49, v49, v49
    v_cvt_pk_bf16_f32 v50, v50, v50
    s_nop 1
    v_and_b32_dpp v20, v43, v16 row_newbcast:0 row_mask:0xf bank_mask:0xf
    v_and_b32_dpp v21, v43, v17 row_newbcast:0 row_mask:0xf bank_mask:0xf
    v_and_b32_dpp v22, v43, v18 row_newbcast:0 row_mask:0xf bank_mask:0xf
    v_and_b32_dpp v23, v43, v19 row_newbcast:0 row_mask:0xf bank_mask:0xf
    v_and_b32_dpp v24, v43, v16 row_newbcast:4 row_mask:0xf bank_mask:0xf
    v_and_b32_dpp v25, v43, v17 row_newbcast:4 row_mask:0xf bank_mask:0xf
    v_and_b32_dpp v26, v43, v18 row_newbcast:4 row_mask:0xf bank_mask:0xf
    v_and_b32_dpp v27, v43, v19 row_newbcast:4 row_mask:0xf bank_mask:0xf
    v_and_b32_dpp v28, v43, v16 row_newbcast:8 row_mask:0xf bank_mask:0xf
    v_and_b32_dpp v29, v43, v17 row_newbcast:8 row_mask:0xf bank_mask:0xf
    v_and_b32_dpp v30, v43, v18 row_newbcast:8 row_mask:0xf bank_mask:0xf
    v_and_b32_dpp v31, v43, v19 row_newbcast:8 row_mask:0xf bank_mask:0xf
    v_and_b32_dpp v32, v43, v16 row_newbcast:12 row_mask:0xf bank_mask:0xf
    v_and_b32_dpp v33, v43, v17 row_newbcast:12 row_mask:0xf bank_mask:0xf
    v_and_b32_dpp v34, v43, v18 row_newbcast:12 row_mask:0xf bank_mask:0xf
    v_and_b32_dpp v35, v43, v19 row_newbcast:12 row_mask:0xf bank_mask:0xf
    s_waitcnt vmcnt(4)
    s_nop 0
    v_mfma_f32_16x16x32_bf16 v[8:11], v[20:23], v[96:99], v[8:11]
    v_mfma_f32_16x16x32_bf16 v[8:11], v[24:27], v[100:103], v[8:11]
    v_mfma_f32_16x16x32_bf16 v[8:11], v[28:31], v[104:107], v[8:11]
    v_mfma_f32_16x16x32_bf16 v[8:11], v[32:35], v[108:111], v[8:11]
    v_xor_b32 v2, 16384, v2
    global_load_dwordx4 v[96:99], v2, s[8:9] nt
    global_load_dwordx4 v[100:103], v2, s[8:9] offset:256 nt
    global_load_dwordx4 v[104:107], v2, s[8:9] offset:512 nt
    global_load_dwordx4 v[108:111], v2, s[8:9] offset:768 nt
    v_fma_f32 v51, v51, v5, -s22
    v_exp_f32 v51, v51
    s_nop 0
    v_add_f32 v4, v4, v51
    v_add_f32 v7, v7, v4
    v_cvt_pk_bf16_f32 v51, v51, v51
    s_nop 1
    v_add_f32_dpp v7, v7, v7 row_ror:4 row_mask:0xf bank_mask:0xf
    s_nop 1
    v_add_f32_dpp v7, v7, v7 row_ror:8 row_mask:0xf bank_mask:0xf
    s_nop 1
    v_add_f32_dpp v7, v7, v7 row_bcast:15 row_mask:0xa bank_mask:0xf
    s_nop 1
    v_add_f32_dpp v7, v7, v7 row_bcast:31 row_mask:0xc bank_mask:0xf
    s_nop 1
    s_lshl_b32 s3, s16, 3
    v_mov_b32 v3, s3
    s_brev_b64 exec, 1
    ds_write_b64 v3, v[6:7] offset:2048
    s_mov_b64 exec, -1
    v_and_b32_dpp v20, v44, v16 row_newbcast:0 row_mask:0xf bank_mask:0xf
    v_and_b32_dpp v21, v44, v17 row_newbcast:0 row_mask:0xf bank_mask:0xf
    v_and_b32_dpp v22, v44, v18 row_newbcast:0 row_mask:0xf bank_mask:0xf
    v_and_b32_dpp v23, v44, v19 row_newbcast:0 row_mask:0xf bank_mask:0xf
    v_and_b32_dpp v24, v44, v16 row_newbcast:4 row_mask:0xf bank_mask:0xf
    v_and_b32_dpp v25, v44, v17 row_newbcast:4 row_mask:0xf bank_mask:0xf
    v_and_b32_dpp v26, v44, v18 row_newbcast:4 row_mask:0xf bank_mask:0xf
    v_and_b32_dpp v27, v44, v19 row_newbcast:4 row_mask:0xf bank_mask:0xf
    v_and_b32_dpp v28, v44, v16 row_newbcast:8 row_mask:0xf bank_mask:0xf
    v_and_b32_dpp v29, v44, v17 row_newbcast:8 row_mask:0xf bank_mask:0xf
    v_and_b32_dpp v30, v44, v18 row_newbcast:8 row_mask:0xf bank_mask:0xf
    v_and_b32_dpp v31, v44, v19 row_newbcast:8 row_mask:0xf bank_mask:0xf
    v_and_b32_dpp v32, v44, v16 row_newbcast:12 row_mask:0xf bank_mask:0xf
    v_and_b32_dpp v33, v44, v17 row_newbcast:12 row_mask:0xf bank_mask:0xf
    v_and_b32_dpp v34, v44, v18 row_newbcast:12 row_mask:0xf bank_mask:0xf
    v_and_b32_dpp v35, v44, v19 row_newbcast:12 row_mask:0xf bank_mask:0xf
    s_waitcnt vmcnt(4)
    s_nop 0
    v_mfma_f32_16x16x32_bf16 v[12:15], v[20:23], v[80:83], 0
    v_mfma_f32_16x16x32_bf16 v[12:15], v[24:27], v[84:87], v[12:15]
    v_mfma_f32_16x16x32_bf16 v[12:15], v[28:31], v[88:91], v[12:15]
    v_mfma_f32_16x16x32_bf16 v[12:15], v[32:35], v[92:95], v[12:15]
    v_xor_b32 v2, 81920, v2
    global_load_dwordx4 v[80:83], v2, s[8:9] nt
    global_load_dwordx4 v[84:87], v2, s[8:9] offset:256 nt
    global_load_dwordx4 v[88:91], v2, s[8:9] offset:512 nt
    global_load_dwordx4 v[92:95], v2, s[8:9] offset:768 nt
    v_and_b32_dpp v20, v45, v16 row_newbcast:0 row_mask:0xf bank_mask:0xf
    v_and_b32_dpp v21, v45, v17 row_newbcast:0 row_mask:0xf bank_mask:0xf
    v_and_b32_dpp v22, v45, v18 row_newbcast:0 row_mask:0xf bank_mask:0xf
    v_and_b32_dpp v23, v45, v19 row_newbcast:0 row_mask:0xf bank_mask:0xf
    v_and_b32_dpp v24, v45, v16 row_newbcast:4 row_mask:0xf bank_mask:0xf
    v_and_b32_dpp v25, v45, v17 row_newbcast:4 row_mask:0xf bank_mask:0xf
    v_and_b32_dpp v26, v45, v18 row_newbcast:4 row_mask:0xf bank_mask:0xf
    v_and_b32_dpp v27, v45, v19 row_newbcast:4 row_mask:0xf bank_mask:0xf
    v_and_b32_dpp v28, v45, v16 row_newbcast:8 row_mask:0xf bank_mask:0xf
    v_and_b32_dpp v29, v45, v17 row_newbcast:8 row_mask:0xf bank_mask:0xf
    v_and_b32_dpp v30, v45, v18 row_newbcast:8 row_mask:0xf bank_mask:0xf
    v_and_b32_dpp v31, v45, v19 row_newbcast:8 row_mask:0xf bank_mask:0xf
    v_and_b32_dpp v32, v45, v16 row_newbcast:12 row_mask:0xf bank_mask:0xf
    v_and_b32_dpp v33, v45, v17 row_newbcast:12 row_mask:0xf bank_mask:0xf
    v_and_b32_dpp v34, v45, v18 row_newbcast:12 row_mask:0xf bank_mask:0xf
    v_and_b32_dpp v35, v45, v19 row_newbcast:12 row_mask:0xf bank_mask:0xf
    s_waitcnt vmcnt(4)
    s_nop 0
    v_mfma_f32_16x16x32_bf16 v[12:15], v[20:23], v[96:99], v[12:15]
    v_mfma_f32_16x16x32_bf16 v[12:15], v[24:27], v[100:103], v[12:15]
    v_mfma_f32_16x16x32_bf16 v[12:15], v[28:31], v[104:107], v[12:15]
    v_mfma_f32_16x16x32_bf16 v[12:15], v[32:35], v[108:111], v[12:15]
    v_xor_b32 v2, 16384, v2
    global_load_dwordx4 v[96:99], v2, s[8:9] nt
    global_load_dwordx4 v[100:103], v2, s[8:9] offset:256 nt
    global_load_dwordx4 v[104:107], v2, s[8:9] offset:512 nt
    global_load_dwordx4 v[108:111], v2, s[8:9] offset:768 nt
    v_and_b32_dpp v20, v46, v16 row_newbcast:0 row_mask:0xf bank_mask:0xf
    v_and_b32_dpp v21, v46, v17 row_newbcast:0 row_mask:0xf bank_mask:0xf
    v_and_b32_dpp v22, v46, v18 row_newbcast:0 row_mask:0xf bank_mask:0xf
    v_and_b32_dpp v23, v46, v19 row_newbcast:0 row_mask:0xf bank_mask:0xf
    v_and_b32_dpp v24, v46, v16 row_newbcast:4 row_mask:0xf bank_mask:0xf
    v_and_b32_dpp v25, v46, v17 row_newbcast:4 row_mask:0xf bank_mask:0xf
    v_and_b32_dpp v26, v46, v18 row_newbcast:4 row_mask:0xf bank_mask:0xf
    v_and_b32_dpp v27, v46, v19 row_newbcast:4 row_mask:0xf bank_mask:0xf
    v_and_b32_dpp v28, v46, v16 row_newbcast:8 row_mask:0xf bank_mask:0xf
    v_and_b32_dpp v29, v46, v17 row_newbcast:8 row_mask:0xf bank_mask:0xf
    v_and_b32_dpp v30, v46, v18 row_newbcast:8 row_mask:0xf bank_mask:0xf
    v_and_b32_dpp v31, v46, v19 row_newbcast:8 row_mask:0xf bank_mask:0xf
    v_and_b32_dpp v32, v46, v16 row_newbcast:12 row_mask:0xf bank_mask:0xf
    v_and_b32_dpp v33, v46, v17 row_newbcast:12 row_mask:0xf bank_mask:0xf
    v_and_b32_dpp v34, v46, v18 row_newbcast:12 row_mask:0xf bank_mask:0xf
    v_and_b32_dpp v35, v46, v19 row_newbcast:12 row_mask:0xf bank_mask:0xf
    s_waitcnt vmcnt(4)
    s_nop 0
    v_mfma_f32_16x16x32_bf16 v[12:15], v[20:23], v[80:83], v[12:15]
    v_mfma_f32_16x16x32_bf16 v[12:15], v[24:27], v[84:87], v[12:15]
    v_mfma_f32_16x16x32_bf16 v[12:15], v[28:31], v[88:91], v[12:15]
    v_mfma_f32_16x16x32_bf16 v[12:15], v[32:35], v[92:95], v[12:15]
    v_xor_b32 v2, 344064, v2
    global_load_dwordx4 v[80:83], v2, s[8:9] nt
    global_load_dwordx4 v[84:87], v2, s[8:9] offset:256 nt
    global_load_dwordx4 v[88:91], v2, s[8:9] offset:512 nt
    global_load_dwordx4 v[92:95], v2, s[8:9] offset:768 nt
    v_and_b32_dpp v20, v47, v16 row_newbcast:0 row_mask:0xf bank_mask:0xf
    v_and_b32_dpp v21, v47, v17 row_newbcast:0 row_mask:0xf bank_mask:0xf
    v_and_b32_dpp v22, v47, v18 row_newbcast:0 row_mask:0xf bank_mask:0xf
    v_and_b32_dpp v23, v47, v19 row_newbcast:0 row_mask:0xf bank_mask:0xf
    v_and_b32_dpp v24, v47, v16 row_newbcast:4 row_mask:0xf bank_mask:0xf
    v_and_b32_dpp v25, v47, v17 row_newbcast:4 row_mask:0xf bank_mask:0xf
    v_and_b32_dpp v26, v47, v18 row_newbcast:4 row_mask:0xf bank_mask:0xf
    v_and_b32_dpp v27, v47, v19 row_newbcast:4 row_mask:0xf bank_mask:0xf
    v_and_b32_dpp v28, v47, v16 row_newbcast:8 row_mask:0xf bank_mask:0xf
    v_and_b32_dpp v29, v47, v17 row_newbcast:8 row_mask:0xf bank_mask:0xf
    v_and_b32_dpp v30, v47, v18 row_newbcast:8 row_mask:0xf bank_mask:0xf
    v_and_b32_dpp v31, v47, v19 row_newbcast:8 row_mask:0xf bank_mask:0xf
    v_and_b32_dpp v32, v47, v16 row_newbcast:12 row_mask:0xf bank_mask:0xf
    v_and_b32_dpp v33, v47, v17 row_newbcast:12 row_mask:0xf bank_mask:0xf
    v_and_b32_dpp v34, v47, v18 row_newbcast:12 row_mask:0xf bank_mask:0xf
    v_and_b32_dpp v35, v47, v19 row_newbcast:12 row_mask:0xf bank_mask:0xf
    s_waitcnt vmcnt(4)
    s_nop 0
    v_mfma_f32_16x16x32_bf16 v[12:15], v[20:23], v[96:99], v[12:15]
    v_mfma_f32_16x16x32_bf16 v[12:15], v[24:27], v[100:103], v[12:15]
    v_mfma_f32_16x16x32_bf16 v[12:15], v[28:31], v[104:107], v[12:15]
    v_mfma_f32_16x16x32_bf16 v[12:15], v[32:35], v[108:111], v[12:15]
    v_xor_b32 v2, 16384, v2
    global_load_dwordx4 v[96:99], v2, s[8:9] nt
    global_load_dwordx4 v[100:103], v2, s[8:9] offset:256 nt
    global_load_dwordx4 v[104:107], v2, s[8:9] offset:512 nt
    global_load_dwordx4 v[108:111], v2, s[8:9] offset:768 nt
    s_waitcnt lgkmcnt(0)
    s_barrier
    v_and_b32_dpp v20, v48, v16 row_newbcast:0 row_mask:0xf bank_mask:0xf
    v_and_b32_dpp v21, v48, v17 row_newbcast:0 row_mask:0xf bank_mask:0xf
    v_and_b32_dpp v22, v48, v18 row_newbcast:0 row_mask:0xf bank_mask:0xf
    v_and_b32_dpp v23, v48, v19 row_newbcast:0 row_mask:0xf bank_mask:0xf
    v_and_b32_dpp v24, v48, v16 row_newbcast:4 row_mask:0xf bank_mask:0xf
    v_and_b32_dpp v25, v48, v17 row_newbcast:4 row_mask:0xf bank_mask:0xf
    v_and_b32_dpp v26, v48, v18 row_newbcast:4 row_mask:0xf bank_mask:0xf
    v_and_b32_dpp v27, v48, v19 row_newbcast:4 row_mask:0xf bank_mask:0xf
    v_and_b32_dpp v28, v48, v16 row_newbcast:8 row_mask:0xf bank_mask:0xf
    v_and_b32_dpp v29, v48, v17 row_newbcast:8 row_mask:0xf bank_mask:0xf
    v_and_b32_dpp v30, v48, v18 row_newbcast:8 row_mask:0xf bank_mask:0xf
    v_and_b32_dpp v31, v48, v19 row_newbcast:8 row_mask:0xf bank_mask:0xf
    v_and_b32_dpp v32, v48, v16 row_newbcast:12 row_mask:0xf bank_mask:0xf
    v_and_b32_dpp v33, v48, v17 row_newbcast:12 row_mask:0xf bank_mask:0xf
    v_and_b32_dpp v34, v48, v18 row_newbcast:12 row_mask:0xf bank_mask:0xf
    v_and_b32_dpp v35, v48, v19 row_newbcast:12 row_mask:0xf bank_mask:0xf
    s_waitcnt vmcnt(4)
    s_nop 0
    v_mfma_f32_16x16x32_bf16 v[12:15], v[20:23], v[80:83], v[12:15]
    v_mfma_f32_16x16x32_bf16 v[12:15], v[24:27], v[84:87], v[12:15]
    v_mfma_f32_16x16x32_bf16 v[12:15], v[28:31], v[88:91], v[12:15]
    v_mfma_f32_16x16x32_bf16 v[12:15], v[32:35], v[92:95], v[12:15]
    v_xor_b32 v2, 81920, v2
    global_load_dwordx4 v[80:83], v2, s[8:9] nt
    global_load_dwordx4 v[84:87], v2, s[8:9] offset:256 nt
    global_load_dwordx4 v[88:91], v2, s[8:9] offset:512 nt
    global_load_dwordx4 v[92:95], v2, s[8:9] offset:768 nt
    v_and_b32_dpp v20, v49, v16 row_newbcast:0 row_mask:0xf bank_mask:0xf
    v_and_b32_dpp v21, v49, v17 row_newbcast:0 row_mask:0xf bank_mask:0xf
    v_and_b32_dpp v22, v49, v18 row_newbcast:0 row_mask:0xf bank_mask:0xf
    v_and_b32_dpp v23, v49, v19 row_newbcast:0 row_mask:0xf bank_mask:0xf
    v_and_b32_dpp v24, v49, v16 row_newbcast:4 row_mask:0xf bank_mask:0xf
    v_and_b32_dpp v25, v49, v17 row_newbcast:4 row_mask:0xf bank_mask:0xf
    v_and_b32_dpp v26, v49, v18 row_newbcast:4 row_mask:0xf bank_mask:0xf
    v_and_b32_dpp v27, v49, v19 row_newbcast:4 row_mask:0xf bank_mask:0xf
    v_and_b32_dpp v28, v49, v16 row_newbcast:8 row_mask:0xf bank_mask:0xf
    v_and_b32_dpp v29, v49, v17 row_newbcast:8 row_mask:0xf bank_mask:0xf
    v_and_b32_dpp v30, v49, v18 row_newbcast:8 row_mask:0xf bank_mask:0xf
    v_and_b32_dpp v31, v49, v19 row_newbcast:8 row_mask:0xf bank_mask:0xf
    v_and_b32_dpp v32, v49, v16 row_newbcast:12 row_mask:0xf bank_mask:0xf
    v_and_b32_dpp v33, v49, v17 row_newbcast:12 row_mask:0xf bank_mask:0xf
    v_and_b32_dpp v34, v49, v18 row_newbcast:12 row_mask:0xf bank_mask:0xf
    v_and_b32_dpp v35, v49, v19 row_newbcast:12 row_mask:0xf bank_mask:0xf
    s_waitcnt vmcnt(4)
    s_nop 0
    v_mfma_f32_16x16x32_bf16 v[12:15], v[20:23], v[96:99], v[12:15]
    v_mfma_f32_16x16x32_bf16 v[12:15], v[24:27], v[100:103], v[12:15]
    v_mfma_f32_16x16x32_bf16 v[12:15], v[28:31], v[104:107], v[12:15]
    v_mfma_f32_16x16x32_bf16 v[12:15], v[32:35], v[108:111], v[12:15]
    v_xor_b32 v2, 16384, v2
    global_load_dwordx4 v[96:99], v2, s[8:9] nt
    global_load_dwordx4 v[100:103], v2, s[8:9] offset:256 nt
    global_load_dwordx4 v[104:107], v2, s[8:9] offset:512 nt
    global_load_dwordx4 v[108:111], v2, s[8:9] offset:768 nt
    v_and_b32_dpp v20, v50, v16 row_newbcast:0 row_mask:0xf bank_mask:0xf
    v_and_b32_dpp v21, v50, v17 row_newbcast:0 row_mask:0xf bank_mask:0xf
    v_and_b32_dpp v22, v50, v18 row_newbcast:0 row_mask:0xf bank_mask:0xf
    v_and_b32_dpp v23, v50, v19 row_newbcast:0 row_mask:0xf bank_mask:0xf
    v_and_b32_dpp v24, v50, v16 row_newbcast:4 row_mask:0xf bank_mask:0xf
    v_and_b32_dpp v25, v50, v17 row_newbcast:4 row_mask:0xf bank_mask:0xf
    v_and_b32_dpp v26, v50, v18 row_newbcast:4 row_mask:0xf bank_mask:0xf
    v_and_b32_dpp v27, v50, v19 row_newbcast:4 row_mask:0xf bank_mask:0xf
    v_and_b32_dpp v28, v50, v16 row_newbcast:8 row_mask:0xf bank_mask:0xf
    v_and_b32_dpp v29, v50, v17 row_newbcast:8 row_mask:0xf bank_mask:0xf
    v_and_b32_dpp v30, v50, v18 row_newbcast:8 row_mask:0xf bank_mask:0xf
    v_and_b32_dpp v31, v50, v19 row_newbcast:8 row_mask:0xf bank_mask:0xf
    v_and_b32_dpp v32, v50, v16 row_newbcast:12 row_mask:0xf bank_mask:0xf
    v_and_b32_dpp v33, v50, v17 row_newbcast:12 row_mask:0xf bank_mask:0xf
    v_and_b32_dpp v34, v50, v18 row_newbcast:12 row_mask:0xf bank_mask:0xf
    v_and_b32_dpp v35, v50, v19 row_newbcast:12 row_mask:0xf bank_mask:0xf
    s_waitcnt vmcnt(4)
    s_nop 0
    v_mfma_f32_16x16x32_bf16 v[12:15], v[20:23], v[80:83], v[12:15]
    v_mfma_f32_16x16x32_bf16 v[12:15], v[24:27], v[84:87], v[12:15]
    v_mfma_f32_16x16x32_bf16 v[12:15], v[28:31], v[88:91], v[12:15]
    v_mfma_f32_16x16x32_bf16 v[12:15], v[32:35], v[92:95], v[12:15]
    v_and_b32_dpp v20, v51, v16 row_newbcast:0 row_mask:0xf bank_mask:0xf
    v_and_b32_dpp v21, v51, v17 row_newbcast:0 row_mask:0xf bank_mask:0xf
    v_and_b32_dpp v22, v51, v18 row_newbcast:0 row_mask:0xf bank_mask:0xf
    v_and_b32_dpp v23, v51, v19 row_newbcast:0 row_mask:0xf bank_mask:0xf
    v_and_b32_dpp v24, v51, v16 row_newbcast:4 row_mask:0xf bank_mask:0xf
    v_and_b32_dpp v25, v51, v17 row_newbcast:4 row_mask:0xf bank_mask:0xf
    v_and_b32_dpp v26, v51, v18 row_newbcast:4 row_mask:0xf bank_mask:0xf
    v_and_b32_dpp v27, v51, v19 row_newbcast:4 row_mask:0xf bank_mask:0xf
    v_and_b32_dpp v28, v51, v16 row_newbcast:8 row_mask:0xf bank_mask:0xf
    v_and_b32_dpp v29, v51, v17 row_newbcast:8 row_mask:0xf bank_mask:0xf
    v_and_b32_dpp v30, v51, v18 row_newbcast:8 row_mask:0xf bank_mask:0xf
    v_and_b32_dpp v31, v51, v19 row_newbcast:8 row_mask:0xf bank_mask:0xf
    v_and_b32_dpp v32, v51, v16 row_newbcast:12 row_mask:0xf bank_mask:0xf
    v_and_b32_dpp v33, v51, v17 row_newbcast:12 row_mask:0xf bank_mask:0xf
    v_and_b32_dpp v34, v51, v18 row_newbcast:12 row_mask:0xf bank_mask:0xf
    v_and_b32_dpp v35, v51, v19 row_newbcast:12 row_mask:0xf bank_mask:0xf
    s_waitcnt vmcnt(3)
    s_nop 0
    v_mfma_f32_16x16x32_bf16 v[12:15], v[20:23], v[96:99], v[12:15]
    s_waitcnt vmcnt(2)
    v_mfma_f32_16x16x32_bf16 v[12:15], v[24:27], v[100:103], v[12:15]
    s_waitcnt vmcnt(1)
    v_mfma_f32_16x16x32_bf16 v[12:15], v[28:31], v[104:107], v[12:15]
    s_waitcnt vmcnt(0)
    v_mfma_f32_16x16x32_bf16 v[12:15], v[32:35], v[108:111], v[12:15]
    s_nop 7
    v_pk_add_f32 v[12:13], v[12:13], v[8:9]
    v_pk_add_f32 v[14:15], v[14:15], v[10:11]
    ds_write_b128 v74, v[12:15]
    s_waitcnt lgkmcnt(0)
    s_barrier
    s_endpgm
L_finisher:
    s_setprio 3
    s_lshl_b32 s24, s17, 13
    s_lshl_b32 s25, s18, 9
    s_add_u32 s25, s25, s24
    s_lshl_b32 s26, s17, 2
    s_mov_b32 s28, s18
    s_getreg_b32 s30, hwreg(HW_REG_XCC_ID, 0, 4)
    s_or_b32 s30, s30, 0x100
    s_mov_b32 s33, 0
    s_mov_b32 s34, 0x01010101
    s_mov_b32 s35, s34
    v_lshl_add_u32 v73, v0, 3, s25
    v_min_u32 v76, 32, v0
    v_lshl_add_u32 v76, v76, 7, s24
    v_lshl_add_u32 v70, v0, 3, s24
    v_lshl_add_u32 v71, v0, 4, s24
    s_add_u32 s3, s24, 4096
    v_and_b32 v72, 7, v0
    v_lshl_add_u32 v72, v72, 3, s3
    s_lshl_b32 s21, s18, 3
    s_add_u32 s21, s21, s3
    v_mov_b32 v77, s21
    v_mov_b32 v52, -1
    v_mov_b32 v53, -1
    v_mov_b32 v54, -1
    v_mov_b32 v55, -1
    s_lshl_b32 s20, s17, 8
    v_and_b32 v74, 3, v0
    v_lshlrev_b32 v74, 3, v74
    v_lshlrev_b32 v1, 3, v0
    v_lshl_add_u32 v2, v0, 2, s20
    s_cmp_lg_u32 s28, 0
    s_waitcnt lgkmcnt(0)
    s_cbranch_scc1 L_barA
    global_load_dword v76, v76, s[14:15] sc1
    s_waitcnt vmcnt(0)
    global_store_dwordx4 v71, v[52:55], s[14:15] offset:0
    global_store_dwordx4 v71, v[52:55], s[14:15] offset:1024
    global_store_dwordx4 v71, v[52:55], s[14:15] offset:2048
    global_store_dwordx4 v71, v[52:55], s[14:15] offset:3072
    global_store_dwordx2 v72, v[52:53], s[14:15]
    v_mov_b32 v3, s26
    v_mov_b32 v4, s30
    s_mov_b64 exec, 1
    s_waitcnt vmcnt(0)
    global_store_dword v3, v4, s[12:13]
    s_mov_b64 exec, -1
L_barA:
    s_barrier
    s_load_dword s33, s[12:13], s26
    ds_read_b64 v[6:7], v74 offset:2048
    s_waitcnt vmcnt(0) lgkmcnt(0)
    v_max_f32_dpp v3, v6, v6 row_ror:1 row_mask:0xf bank_mask:0xf
    s_nop 1
    v_max_f32_dpp v3, v3, v3 row_ror:2 row_mask:0xf bank_mask:0xf
    v_sub_f32 v5, v6, v3
    v_exp_f32 v5, v5
    v_min_u32 v6, -2, v3
    v_mul_f32 v7, v7, v5
    s_nop 1
    v_add_f32_dpp v7, v7, v7 row_ror:1 row_mask:0xf bank_mask:0xf
    s_nop 1
    v_add_f32_dpp v7, v7, v7 row_ror:2 row_mask:0xf bank_mask:0xf
    s_mov_b32 s32, 16777216
    s_mov_b32 s31, 0
    v_min_u32 v7, -2, v7
    s_cmp_eq_u32 s33, s30
    s_cselect_b32 s33, 1, 2
    s_cmp_eq_u32 s28, 0
    s_cselect_b32 s28, 0, s33
    s_cmp_lg_u32 s28, 1
    s_cbranch_scc1 L_notfast
    s_mov_b64 exec, 1
    global_store_dwordx2 v77, v[6:7], s[14:15]
    s_mov_b64 exec, -1
    s_branch L_barB
L_notfast:
    s_cmp_lg_u32 s28, 0
    s_cbranch_scc1 L_barB
    s_mov_b32 s3, 8
L_mlpoll:
    global_load_dwordx2 v[68:69], v72, s[14:15] sc1
    s_waitcnt vmcnt(0)
    v_cndmask_b32 v68, v68, v6, s[34:35]
    v_cndmask_b32 v69, v69, v7, s[34:35]
    v_max_u32 v3, v68, v69
    v_cmp_eq_u32 vcc, -1, v3
    s_cbranch_vccz L_mlready
    s_sub_u32 s3, s3, 1
    s_cmp_lg_u32 s3, 0
    s_cbranch_scc1 L_mlpoll
    s_branch L_barB
L_mlready:
    v_max_f32_dpp v3, v68, v68 row_ror:1 row_mask:0xf bank_mask:0xf
    s_nop 1
    v_max_f32_dpp v3, v3, v3 row_ror:2 row_mask:0xf bank_mask:0xf
    s_nop 1
    v_max_f32_dpp v3, v3, v3 row_ror:4 row_mask:0xf bank_mask:0xf
    v_sub_f32 v78, v68, v3
    v_exp_f32 v78, v78
    s_nop 0
    v_mul_f32 v3, v69, v78
    s_nop 1
    v_add_f32_dpp v3, v3, v3 row_ror:1 row_mask:0xf bank_mask:0xf
    s_nop 1
    v_add_f32_dpp v3, v3, v3 row_ror:2 row_mask:0xf bank_mask:0xf
    s_nop 1
    v_add_f32_dpp v3, v3, v3 row_ror:4 row_mask:0xf bank_mask:0xf
    v_rcp_f32 v3, v3
    s_mov_b32 s28, -1
    v_mul_f32 v78, v78, v3
    s_barrier
    ds_read_b64 v[80:81], v1 offset:0
    ds_read_b64 v[82:83], v1 offset:512
    ds_read_b64 v[84:85], v1 offset:1024
    ds_read_b64 v[86:87], v1 offset:1536
    global_load_dwordx2 v[54:55], v70, s[14:15] offset:512 sc1
    global_load_dwordx2 v[56:57], v70, s[14:15] offset:1024 sc1
    global_load_dwordx2 v[58:59], v70, s[14:15] offset:1536 sc1
    global_load_dwordx2 v[60:61], v70, s[14:15] offset:2048 sc1
    global_load_dwordx2 v[62:63], v70, s[14:15] offset:2560 sc1
    global_load_dwordx2 v[64:65], v70, s[14:15] offset:3072 sc1
    global_load_dwordx2 v[66:67], v70, s[14:15] offset:3584 sc1
    s_waitcnt lgkmcnt(3)
    v_mul_f32_dpp v12, v5, v80 row_newbcast:0 row_mask:0xf bank_mask:0xf
    v_mul_f32_dpp v13, v5, v81 row_newbcast:0 row_mask:0xf bank_mask:0xf
    s_waitcnt lgkmcnt(2)
    v_fmac_f32_dpp v12, v5, v82 row_newbcast:1 row_mask:0xf bank_mask:0xf
    v_fmac_f32_dpp v13, v5, v83 row_newbcast:1 row_mask:0xf bank_mask:0xf
    s_waitcnt lgkmcnt(1)
    v_fmac_f32_dpp v12, v5, v84 row_newbcast:2 row_mask:0xf bank_mask:0xf
    v_fmac_f32_dpp v13, v5, v85 row_newbcast:2 row_mask:0xf bank_mask:0xf
    s_waitcnt lgkmcnt(0)
    v_fmac_f32_dpp v12, v5, v86 row_newbcast:3 row_mask:0xf bank_mask:0xf
    v_fmac_f32_dpp v13, v5, v87 row_newbcast:3 row_mask:0xf bank_mask:0xf
L_opoll:
    global_load_dwordx2 v[98:99], v70, s[14:15] offset:512 sc1
    global_load_dwordx2 v[100:101], v70, s[14:15] offset:1024 sc1
    global_load_dwordx2 v[102:103], v70, s[14:15] offset:1536 sc1
    global_load_dwordx2 v[104:105], v70, s[14:15] offset:2048 sc1
    global_load_dwordx2 v[106:107], v70, s[14:15] offset:2560 sc1
    global_load_dwordx2 v[108:109], v70, s[14:15] offset:3072 sc1
    global_load_dwordx2 v[110:111], v70, s[14:15] offset:3584 sc1
    v_mul_f32_dpp v14, v78, v12 row_newbcast:0 row_mask:0xf bank_mask:0xf
    v_mul_f32_dpp v15, v78, v13 row_newbcast:0 row_mask:0xf bank_mask:0xf
    s_waitcnt vmcnt(13)
    v_max_u32 v3, v54, v55
    v_fmac_f32_dpp v14, v78, v54 row_newbcast:1 row_mask:0xf bank_mask:0xf
    v_fmac_f32_dpp v15, v78, v55 row_newbcast:1 row_mask:0xf bank_mask:0xf
    s_waitcnt vmcnt(12)
    v_max3_u32 v3, v3, v56, v57
    v_fmac_f32_dpp v14, v78, v56 row_newbcast:2 row_mask:0xf bank_mask:0xf
    v_fmac_f32_dpp v15, v78, v57 row_newbcast:2 row_mask:0xf bank_mask:0xf
    s_waitcnt vmcnt(11)
    v_max3_u32 v3, v3, v58, v59
    v_fmac_f32_dpp v14, v78, v58 row_newbcast:3 row_mask:0xf bank_mask:0xf
    v_fmac_f32_dpp v15, v78, v59 row_newbcast:3 row_mask:0xf bank_mask:0xf
    s_waitcnt vmcnt(10)
    v_max3_u32 v3, v3, v60, v61
    v_fmac_f32_dpp v14, v78, v60 row_newbcast:4 row_mask:0xf bank_mask:0xf
    v_fmac_f32_dpp v15, v78, v61 row_newbcast:4 row_mask:0xf bank_mask:0xf
    s_waitcnt vmcnt(9)
    v_max3_u32 v3, v3, v62, v63
    v_fmac_f32_dpp v14, v78, v62 row_newbcast:5 row_mask:0xf bank_mask:0xf
    v_fmac_f32_dpp v15, v78, v63 row_newbcast:5 row_mask:0xf bank_mask:0xf
    s_waitcnt vmcnt(8)
    v_max3_u32 v3, v3, v64, v65
    v_fmac_f32_dpp v14, v78, v64 row_newbcast:6 row_mask:0xf bank_mask:0xf
    v_fmac_f32_dpp v15, v78, v65 row_newbcast:6 row_mask:0xf bank_mask:0xf
    s_waitcnt vmcnt(7)
    v_max3_u32 v3, v3, v66, v67
    v_cmp_eq_u32 vcc, -1, v3
    v_fmac_f32_dpp v14, v78, v66 row_newbcast:7 row_mask:0xf bank_mask:0xf
    v_fmac_f32_dpp v15, v78, v67 row_newbcast:7 row_mask:0xf bank_mask:0xf
    v_cvt_pk_bf16_f32 v4, v14, v15
    s_cbranch_vccz L_oready
    global_load_dwordx2 v[54:55], v70, s[14:15] offset:512 sc1
    global_load_dwordx2 v[56:57], v70, s[14:15] offset:1024 sc1
    global_load_dwordx2 v[58:59], v70, s[14:15] offset:1536 sc1
    global_load_dwordx2 v[60:61], v70, s[14:15] offset:2048 sc1
    global_load_dwordx2 v[62:63], v70, s[14:15] offset:2560 sc1
    global_load_dwordx2 v[64:65], v70, s[14:15] offset:3072 sc1
    global_load_dwordx2 v[66:67], v70, s[14:15] offset:3584 sc1
    v_mul_f32_dpp v14, v78, v12 row_newbcast:0 row_mask:0xf bank_mask:0xf
    v_mul_f32_dpp v15, v78, v13 row_newbcast:0 row_mask:0xf bank_mask:0xf
    s_waitcnt vmcnt(13)
    v_max_u32 v3, v98, v99
    v_fmac_f32_dpp v14, v78, v98 row_newbcast:1 row_mask:0xf bank_mask:0xf
    v_fmac_f32_dpp v15, v78, v99 row_newbcast:1 row_mask:0xf bank_mask:0xf
    s_waitcnt vmcnt(12)
    v_max3_u32 v3, v3, v100, v101
    v_fmac_f32_dpp v14, v78, v100 row_newbcast:2 row_mask:0xf bank_mask:0xf
    v_fmac_f32_dpp v15, v78, v101 row_newbcast:2 row_mask:0xf bank_mask:0xf
    s_waitcnt vmcnt(11)
    v_max3_u32 v3, v3, v102, v103
    v_fmac_f32_dpp v14, v78, v102 row_newbcast:3 row_mask:0xf bank_mask:0xf
    v_fmac_f32_dpp v15, v78, v103 row_newbcast:3 row_mask:0xf bank_mask:0xf
    s_waitcnt vmcnt(10)
    v_max3_u32 v3, v3, v104, v105
    v_fmac_f32_dpp v14, v78, v104 row_newbcast:4 row_mask:0xf bank_mask:0xf
    v_fmac_f32_dpp v15, v78, v105 row_newbcast:4 row_mask:0xf bank_mask:0xf
    s_waitcnt vmcnt(9)
    v_max3_u32 v3, v3, v106, v107
    v_fmac_f32_dpp v14, v78, v106 row_newbcast:5 row_mask:0xf bank_mask:0xf
    v_fmac_f32_dpp v15, v78, v107 row_newbcast:5 row_mask:0xf bank_mask:0xf
    s_waitcnt vmcnt(8)
    v_max3_u32 v3, v3, v108, v109
    v_fmac_f32_dpp v14, v78, v108 row_newbcast:6 row_mask:0xf bank_mask:0xf
    v_fmac_f32_dpp v15, v78, v109 row_newbcast:6 row_mask:0xf bank_mask:0xf
    s_waitcnt vmcnt(7)
    v_max3_u32 v3, v3, v110, v111
    v_cmp_eq_u32 vcc, -1, v3
    v_fmac_f32_dpp v14, v78, v110 row_newbcast:7 row_mask:0xf bank_mask:0xf
    v_fmac_f32_dpp v15, v78, v111 row_newbcast:7 row_mask:0xf bank_mask:0xf
    v_cvt_pk_bf16_f32 v4, v14, v15
    s_cbranch_vccz L_oready2
    s_sub_u32 s32, s32, 1
    s_cmp_lg_u32 s32, 0
    s_cbranch_scc1 L_opoll
    s_branch L_fin
L_oready:
L_oready2:
    global_store_dword v2, v4, s[10:11]
    s_endpgm
L_barB:
    s_cmp_eq_u32 s28, 0
    s_barrier
    ds_read_b64 v[80:81], v1 offset:0
    ds_read_b64 v[82:83], v1 offset:512
    ds_read_b64 v[84:85], v1 offset:1024
    ds_read_b64 v[86:87], v1 offset:1536
    s_cbranch_scc0 L_nospec
    global_load_dwordx2 v[68:69], v72, s[14:15] sc1
    global_load_dwordx2 v[54:55], v70, s[14:15] offset:512 sc1
    global_load_dwordx2 v[56:57], v70, s[14:15] offset:1024 sc1
    global_load_dwordx2 v[58:59], v70, s[14:15] offset:1536 sc1
    global_load_dwordx2 v[60:61], v70, s[14:15] offset:2048 sc1
    global_load_dwordx2 v[62:63], v70, s[14:15] offset:2560 sc1
    global_load_dwordx2 v[64:65], v70, s[14:15] offset:3072 sc1
    global_load_dwordx2 v[66:67], v70, s[14:15] offset:3584 sc1
L_nospec:
    s_waitcnt lgkmcnt(3)
    v_mul_f32_dpp v12, v5, v80 row_newbcast:0 row_mask:0xf bank_mask:0xf
    v_mul_f32_dpp v13, v5, v81 row_newbcast:0 row_mask:0xf bank_mask:0xf
    s_waitcnt lgkmcnt(2)
    v_fmac_f32_dpp v12, v5, v82 row_newbcast:1 row_mask:0xf bank_mask:0xf
    v_fmac_f32_dpp v13, v5, v83 row_newbcast:1 row_mask:0xf bank_mask:0xf
    s_waitcnt lgkmcnt(1)
    v_fmac_f32_dpp v12, v5, v84 row_newbcast:2 row_mask:0xf bank_mask:0xf
    v_fmac_f32_dpp v13, v5, v85 row_newbcast:2 row_mask:0xf bank_mask:0xf
    s_waitcnt lgkmcnt(0)
    v_fmac_f32_dpp v12, v5, v86 row_newbcast:3 row_mask:0xf bank_mask:0xf
    v_fmac_f32_dpp v13, v5, v87 row_newbcast:3 row_mask:0xf bank_mask:0xf
    s_cmp_lg_u32 s28, 1
    v_min_u32 v52, -2, v12
    v_min_u32 v53, -2, v13
    s_cbranch_scc1 L_other
    global_store_dwordx2 v73, v[52:53], s[14:15]
    s_endpgm
L_other:
    s_cmp_lg_u32 s28, 0
    s_cbranch_scc1 L_slowput
    s_branch L_check
L_poll:
    global_load_dwordx2 v[68:69], v72, s[14:15] sc1
    global_load_dwordx2 v[54:55], v70, s[14:15] offset:512 sc1
    global_load_dwordx2 v[56:57], v70, s[14:15] offset:1024 sc1
    global_load_dwordx2 v[58:59], v70, s[14:15] offset:1536 sc1
    global_load_dwordx2 v[60:61], v70, s[14:15] offset:2048 sc1
    global_load_dwordx2 v[62:63], v70, s[14:15] offset:2560 sc1
    global_load_dwordx2 v[64:65], v70, s[14:15] offset:3072 sc1
    global_load_dwordx2 v[66:67], v70, s[14:15] offset:3584 sc1
L_check:
    s_waitcnt vmcnt(7)
    v_cndmask_b32 v68, v68, v6, s[34:35]
    v_cndmask_b32 v69, v69, v7, s[34:35]
    v_max_u32 v3, v68, v69
    s_waitcnt vmcnt(6)
    v_max3_u32 v3, v3, v54, v55
    s_waitcnt vmcnt(5)
    v_max3_u32 v3, v3, v56, v57
    s_waitcnt vmcnt(4)
    v_max3_u32 v3, v3, v58, v59
    s_waitcnt vmcnt(3)
    v_max3_u32 v3, v3, v60, v61
    s_waitcnt vmcnt(2)
    v_max3_u32 v3, v3, v62, v63
    s_waitcnt vmcnt(1)
    v_max3_u32 v3, v3, v64, v65
    s_waitcnt vmcnt(0)
    v_max3_u32 v3, v3, v66, v67
    v_cmp_eq_u32 vcc, -1, v3
    s_cbranch_vccz L_ready
    s_sub_u32 s32, s32, 1
    s_and_b32 s3, s32, 7
    s_cselect_b32 s3, s31, 1
    s_cmp_eq_u32 s3, 0
    s_cbranch_scc1 L_poll
    s_branch L_slowpoll
L_ready:
    v_max_f32_dpp v3, v68, v68 row_ror:1 row_mask:0xf bank_mask:0xf
    s_nop 1
    v_max_f32_dpp v3, v3, v3 row_ror:2 row_mask:0xf bank_mask:0xf
    s_nop 1
    v_max_f32_dpp v3, v3, v3 row_ror:4 row_mask:0xf bank_mask:0xf
    v_sub_f32 v78, v68, v3
    v_exp_f32 v78, v78
    s_nop 0
    v_mul_f32 v3, v69, v78
    s_nop 1
    v_add_f32_dpp v3, v3, v3 row_ror:1 row_mask:0xf bank_mask:0xf
    s_nop 1
    v_add_f32_dpp v3, v3, v3 row_ror:2 row_mask:0xf bank_mask:0xf
    s_nop 1
    v_add_f32_dpp v3, v3, v3 row_ror:4 row_mask:0xf bank_mask:0xf
    v_rcp_f32 v3, v3
    s_nop 0
    v_mul_f32 v78, v78, v3
    s_nop 1
    v_mul_f32_dpp v12, v78, v52 row_newbcast:0 row_mask:0xf bank_mask:0xf
    v_mul_f32_dpp v13, v78, v53 row_newbcast:0 row_mask:0xf bank_mask:0xf
    s_nop 0
    v_fmac_f32_dpp v12, v78, v54 row_newbcast:1 row_mask:0xf bank_mask:0xf
    v_fmac_f32_dpp v13, v78, v55 row_newbcast:1 row_mask:0xf bank_mask:0xf
    s_nop 0
    v_fmac_f32_dpp v12, v78, v56 row_newbcast:2 row_mask:0xf bank_mask:0xf
    v_fmac_f32_dpp v13, v78, v57 row_newbcast:2 row_mask:0xf bank_mask:0xf
    s_nop 0
    v_fmac_f32_dpp v12, v78, v58 row_newbcast:3 row_mask:0xf bank_mask:0xf
    v_fmac_f32_dpp v13, v78, v59 row_newbcast:3 row_mask:0xf bank_mask:0xf
    s_nop 0
    v_fmac_f32_dpp v12, v78, v60 row_newbcast:4 row_mask:0xf bank_mask:0xf
    v_fmac_f32_dpp v13, v78, v61 row_newbcast:4 row_mask:0xf bank_mask:0xf
    s_nop 0
    v_fmac_f32_dpp v12, v78, v62 row_newbcast:5 row_mask:0xf bank_mask:0xf
    v_fmac_f32_dpp v13, v78, v63 row_newbcast:5 row_mask:0xf bank_mask:0xf
    s_nop 0
    v_fmac_f32_dpp v12, v78, v64 row_newbcast:6 row_mask:0xf bank_mask:0xf
    v_fmac_f32_dpp v13, v78, v65 row_newbcast:6 row_mask:0xf bank_mask:0xf
    s_nop 0
    v_fmac_f32_dpp v12, v78, v66 row_newbcast:7 row_mask:0xf bank_mask:0xf
    v_fmac_f32_dpp v13, v78, v67 row_newbcast:7 row_mask:0xf bank_mask:0xf
    s_nop 0
    v_cvt_pk_bf16_f32 v12, v12, v13
    global_store_dword v2, v12, s[10:11]
L_stored:
    s_endpgm
L_slowput:
    v_add_u32 v73, 262144, v73
    s_lshl_b32 s3, s18, 8
    s_add_u32 s3, s3, s24
    s_add_u32 s3, s3, 266240
    v_mov_b32 v77, s3
    global_store_dwordx2 v73, v[52:53], s[14:15] sc1
    s_mov_b64 exec, 1
    global_store_dwordx2 v77, v[6:7], s[14:15] sc1
    s_lshl_b32 s3, 1, s18
    v_mov_b32 v3, s26
    v_mov_b32 v4, s3
    s_waitcnt vmcnt(0)
    global_atomic_or v3, v4, s[12:13] offset:128
    s_endpgm
L_slowpoll:
    s_cmp_eq_u32 s32, 0
    s_cbranch_scc1 L_fin
    v_mov_b32 v3, s26
    global_load_dword v4, v3, s[12:13] offset:128 sc1
    v_and_b32 v3, 7, v0
    s_waitcnt vmcnt(0)
    v_readfirstlane_b32 s31, v4
    v_lshrrev_b32 v4, v3, v4
    v_and_b32 v4, 1, v4
    v_cmp_eq_u32 vcc, 1, v4
    s_add_u32 s3, s24, 266240
    v_lshl_add_u32 v3, v3, 8, s3
    s_and_b32 s31, s31, 0xff
    v_cndmask_b32 v4, v72, v3, vcc
    global_load_dwordx2 v[68:69], v4, s[14:15] sc1
    s_bitcmp1_b32 s31, 1
    s_cselect_b32 s3, 262144, 0
    v_add_u32 v4, s3, v70
    global_load_dwordx2 v[54:55], v4, s[14:15] offset:512 sc1
    s_bitcmp1_b32 s31, 2
    s_cselect_b32 s3, 262144, 0
    v_add_u32 v4, s3, v70
    global_load_dwordx2 v[56:57], v4, s[14:15] offset:1024 sc1
    s_bitcmp1_b32 s31, 3
    s_cselect_b32 s3, 262144, 0
    v_add_u32 v4, s3, v70
    global_load_dwordx2 v[58:59], v4, s[14:15] offset:1536 sc1
    s_bitcmp1_b32 s31, 4
    s_cselect_b32 s3, 262144, 0
    v_add_u32 v4, s3, v70
    global_load_dwordx2 v[60:61], v4, s[14:15] offset:2048 sc1
    s_bitcmp1_b32 s31, 5
    s_cselect_b32 s3, 262144, 0
    v_add_u32 v4, s3, v70
    global_load_dwordx2 v[62:63], v4, s[14:15] offset:2560 sc1
    s_bitcmp1_b32 s31, 6
    s_cselect_b32 s3, 262144, 0
    v_add_u32 v4, s3, v70
    global_load_dwordx2 v[64:65], v4, s[14:15] offset:3072 sc1
    s_bitcmp1_b32 s31, 7
    s_cselect_b32 s3, 262144, 0
    v_add_u32 v4, s3, v70
    global_load_dwordx2 v[66:67], v4, s[14:15] offset:3584 sc1
    s_branch L_check
L_fin:
L_end:
    s_endpgm
.section .rodata,"a"
.p2align 6
.amdhsa_kernel standalone__mha_softmax__decode_kernel
  .amdhsa_next_free_vgpr 112
  .amdhsa_next_free_sgpr 48
  .amdhsa_accum_offset 112
  .amdhsa_group_segment_fixed_size 0
  .amdhsa_kernarg_size 48
  .amdhsa_user_sgpr_count 2
  .amdhsa_user_sgpr_kernarg_segment_ptr 1
  .amdhsa_system_sgpr_workgroup_id_x 1
  .amdhsa_float_denorm_mode_32 3
.end_amdhsa_kernel
```
